```python
import torch

def _softmax(x, axis=-1):
    return torch.softmax(x, dim=axis)
def _gelu(x):
    return torch.nn.functional.gelu(x, approximate="tanh")
def _silu(x):
    return torch.nn.functional.silu(x)
def _sigmoid(x):
    return torch.sigmoid(x)
def _layernorm(x, axis=-1, eps=1e-5):
    m = x.mean(dim=axis, keepdim=True)
    v = x.var(dim=axis, keepdim=True, unbiased=False)
    return (x - m) / torch.sqrt(v + eps)
def _scatter_add(tgt, idx, src, axis=0):
    return tgt.clone().index_add_(axis, idx, src)
def _segment_sum(src, seg, n):
    out = torch.zeros((n,) + src.shape[1:], dtype=src.dtype)
    return out.index_add_(0, seg, src)
def _pad(x, pw):
    flat = tuple(v for pair in reversed(pw) for v in pair)
    return torch.nn.functional.pad(x, flat)

kernel_name = 'concat_heads__mha_block_cached__mha_block_cached__near_ridge'

def setup_inputs():

    _w = (lambda a: (lambda t: t.to(torch.bfloat16) if t.is_floating_point() else t)(torch.as_tensor(a)))
    def _A_setup():
        B, Sq, D = 8, 192, 512
        H, Sk, Dh = 32, 512, 128
        return {
            "x": _w((lambda *s: torch.randn(*s, dtype=torch.bfloat16) * 0.8)(B, Sq, D)),
            "k_cache": _w((lambda *s: torch.randn(*s, dtype=torch.bfloat16) * 0.8)(B, H, Sk, Dh)),
            "v_cache": _w((lambda *s: torch.randn(*s, dtype=torch.bfloat16) * 0.05)(B, H, Sk, Dh)),
            "wq": _w((lambda *s: torch.randn(*s, dtype=torch.bfloat16) * 0.8)(D, H * Dh) * (D ** -0.5)),
            "wo": _w((lambda *s: torch.randn(*s, dtype=torch.bfloat16) * 0.05)(H * Dh, D) * ((H * Dh) ** -0.5)),
        }
    _A_in = _A_setup()

    def _B_setup():
        B, Sq, D = 8, 192, 512
        H, Sk, Dh = 32, 512, 128
        return {
            "x": _w((lambda *s: torch.randn(*s, dtype=torch.bfloat16) * 0.8)(B, Sq, D)),
            "k_cache": _w((lambda *s: torch.randn(*s, dtype=torch.bfloat16) * 0.8)(B, H, Sk, Dh)),
            "v_cache": _w((lambda *s: torch.randn(*s, dtype=torch.bfloat16) * 0.05)(B, H, Sk, Dh)),
            "wq": _w((lambda *s: torch.randn(*s, dtype=torch.bfloat16) * 0.8)(D, H * Dh) * (D ** -0.5)),
            "wo": _w((lambda *s: torch.randn(*s, dtype=torch.bfloat16) * 0.05)(H * Dh, D) * ((H * Dh) ** -0.5)),
        }
    _B_in = _B_setup()

    return {
        "A_x": _A_in["x"],
        "A_k_cache": _A_in["k_cache"],
        "A_v_cache": _A_in["v_cache"],
        "A_wq": _A_in["wq"],
        "A_wo": _A_in["wo"],
        "B_x": _B_in["x"],
        "B_k_cache": _B_in["k_cache"],
        "B_v_cache": _B_in["v_cache"],
        "B_wq": _B_in["wq"],
        "B_wo": _B_in["wo"],
    }

def reference(A_x, A_k_cache, A_v_cache, A_wq, A_wo, B_x, B_k_cache, B_v_cache, B_wq, B_wo):
    def _A_ref(x, k_cache, v_cache, wq, wo):
        B, Sq, D = x.shape
        H, Dh = 32, 128
        q = (lambda x, *d: x.permute(*d))((x @ wq).reshape(B, Sq, H, Dh), 0, 2, 1, 3)
        scores = torch.einsum("bhqd,bhkd->bhqk", q, k_cache) * (Dh ** -0.5)
        p = _softmax(scores, axis=-1)
        o = torch.einsum("bhqk,bhkd->bhqd", p, v_cache)
        return (lambda x, *d: x.permute(*d))(o, 0, 2, 1, 3).reshape(B, Sq, H * Dh) @ wo

    def _B_ref(x, k_cache, v_cache, wq, wo):
        B, Sq, D = x.shape
        H, Dh = 32, 128
        q = (lambda x, *d: x.permute(*d))((x @ wq).reshape(B, Sq, H, Dh), 0, 2, 1, 3)
        scores = torch.einsum("bhqd,bhkd->bhqk", q, k_cache) * (Dh ** -0.5)
        p = _softmax(scores, axis=-1)
        o = torch.einsum("bhqk,bhkd->bhqd", p, v_cache)
        return (lambda x, *d: x.permute(*d))(o, 0, 2, 1, 3).reshape(B, Sq, H * Dh) @ wo

    a = _A_ref(A_x, A_k_cache, A_v_cache, A_wq, A_wo)
    b = _B_ref(B_x, B_k_cache, B_v_cache, B_wq, B_wo)
    return torch.concatenate([a, b], axis=-1)
```

```asm
; @launch kernel=k1_kernel grid=(256,1,1) block=(256,1,1) lds=163840
; @launch kernel=k2_kernel grid=(256,1,1) block=(256,1,1) lds=131072
.amdgcn_target "amdgcn-amd-amdhsa--gfx950"
.text
.globl k1_kernel
.p2align 8
.type k1_kernel,@function
k1_kernel:
  s_cmp_ge_u32 s2, 256
  s_cbranch_scc1 k1_end
  s_load_dwordx16 s[52:67], s[0:1], 0
  s_load_dwordx4 s[68:71], s[0:1], 64
  s_load_dwordx2 s[72:73], s[0:1], 96
  v_lshrrev_b32 v1, 6, v0
  v_and_b32 v0, 63, v0
  s_and_b32 s3, s2, 1
  v_readfirstlane_b32 s28, v1
  s_lshr_b32 s4, s2, 3
  s_and_b32 s5, s4, 7
  s_lshr_b32 s4, s4, 3
  s_bfe_u32 s6, s2, 0x20001
  s_lshl_b32 s6, s6, 2
  s_add_u32 s6, s6, s4
  s_lshr_b32 s29, s28, 1
  s_and_b32 s30, s28, 1
  s_lshl_b32 s7, s6, 1
  s_add_u32 s7, s7, s29
  s_waitcnt lgkmcnt(0)
  s_cmp_eq_u32 s3, 0
  s_cselect_b32 s8, s52, s62
  s_cselect_b32 s9, s53, s63
  s_cselect_b32 s16, s54, s64
  s_cselect_b32 s17, s55, s65
  s_cselect_b32 s20, s56, s66
  s_cselect_b32 s21, s57, s67
  s_cselect_b32 s12, s58, s68
  s_cselect_b32 s13, s59, s69
  s_mul_i32 s31, s5, 196608
  s_add_u32 s8, s8, s31
  s_addc_u32 s9, s9, 0
  s_and_b32 s9, s9, 0xffff
  s_mov_b32 s10, 196608
  s_mov_b32 s11, 0x20000
  s_and_b32 s13, s13, 0xffff
  s_mov_b32 s14, 4194304
  s_mov_b32 s15, 0x20000
  s_lshl_b32 s31, s5, 5
  s_add_u32 s31, s31, s7
  s_lshl_b32 s51, s31, 17
  s_lshr_b32 s31, s31, 15
  s_add_u32 s16, s16, s51
  s_addc_u32 s17, s17, s31
  s_and_b32 s17, s17, 0xffff
  s_mov_b32 s18, 131072
  s_mov_b32 s19, 0x20000
  s_add_u32 s20, s20, s51
  s_addc_u32 s21, s21, s31
  s_and_b32 s21, s21, 0xffff
  s_mov_b32 s22, 131072
  s_mov_b32 s23, 0x20000
  s_mul_i32 s31, s3, 48
  s_mul_i32 s51, s5, 6
  s_add_u32 s31, s31, s51
  s_mul_i32 s51, s30, 3
  s_add_u32 s31, s31, s51
  s_lshl_b32 s31, s31, 8
  s_lshl_b32 s51, s7, 3
  s_add_u32 s31, s31, s51
  s_lshl_b32 s31, s31, 10
  s_add_u32 s24, s72, s31
  s_addc_u32 s25, s73, 0
  s_and_b32 s25, s25, 0xffff
  s_mov_b32 s26, 786432
  s_mov_b32 s27, 0x20000
  v_lshrrev_b32 v25, 4, v0
  v_and_b32 v26, 15, v0
  v_lshlrev_b32 v24, 4, v0
  v_lshlrev_b32 v27, 2, v25
  v_xor_b32 v27, v26, v27
  v_lshlrev_b32 v27, 4, v27
  v_lshl_add_u32 v18, v25, 8, v27
  v_lshl_add_u32 v50, v25, 13, v27
  v_add_u32 v51, 32768, v50
  v_add_u32 v52, 65536, v50
  v_add_u32 v53, 98304, v50
  v_add_u32 v54, 131072, v50
  v_add_u32 v55, 163840, v50
  v_add_u32 v56, 196608, v50
  v_add_u32 v57, 229376, v50
  v_xor_b32 v27, v26, v25
  v_lshlrev_b32 v27, 4, v27
  v_lshl_add_u32 v14, v25, 8, v27
  v_xor_b32 v15, 64, v14
  v_xor_b32 v16, 128, v14
  v_xor_b32 v17, 192, v14
  v_lshrrev_b32 v27, 3, v0
  v_and_b32 v28, 7, v0
  v_xor_b32 v28, v28, v25
  v_lshlrev_b32 v28, 4, v28
  v_lshl_add_u32 v44, v27, 10, v28
  v_add_u32 v45, 8192, v44
  v_xor_b32 v45, 64, v45
  v_add_u32 v46, 16384, v44
  v_add_u32 v47, 24576, v44
  v_xor_b32 v47, 64, v47
  v_add_u32 v48, 32768, v44
  v_add_u32 v49, 40960, v44
  v_xor_b32 v49, 64, v49
  s_mul_i32 s38, s28, 49152
  s_lshl_b32 s39, s30, 18
  s_lshl_b32 s31, s7, 8
  s_add_u32 s39, s39, s31
  s_mul_i32 s40, s28, 6144
  s_lshl_b32 s41, s29, 14
  s_lshl_b32 s31, s30, 13
  s_add_u32 s41, s41, s31
  s_lshl_b32 s50, s29, 14
  s_lshl_b32 s31, s30, 12
  s_add_u32 s50, s50, s31
  s_add_u32 m0, s40, 0
  s_nop 0
  buffer_load_dwordx4 v44, s[8:11], s38 offen lds
  s_add_u32 m0, s40, 1024
  s_nop 0
  buffer_load_dwordx4 v45, s[8:11], s38 offen lds
  s_add_u32 m0, s40, 2048
  s_nop 0
  buffer_load_dwordx4 v46, s[8:11], s38 offen lds
  s_add_u32 m0, s40, 3072
  s_nop 0
  buffer_load_dwordx4 v47, s[8:11], s38 offen lds
  s_add_u32 m0, s40, 4096
  s_nop 0
  buffer_load_dwordx4 v48, s[8:11], s38 offen lds
  s_add_u32 m0, s40, 5120
  s_nop 0
  buffer_load_dwordx4 v49, s[8:11], s38 offen lds
  s_add_u32 m0, s41, 24576
  s_nop 0
  buffer_load_dwordx4 v50, s[12:15], s39 offen lds
  s_add_u32 m0, s41, 25600
  s_nop 0
  buffer_load_dwordx4 v51, s[12:15], s39 offen lds
  s_add_u32 m0, s41, 26624
  s_nop 0
  buffer_load_dwordx4 v52, s[12:15], s39 offen lds
  s_add_u32 m0, s41, 27648
  s_nop 0
  buffer_load_dwordx4 v53, s[12:15], s39 offen lds
  s_add_u32 m0, s41, 28672
  s_nop 0
  buffer_load_dwordx4 v54, s[12:15], s39 offen lds
  s_add_u32 m0, s41, 29696
  s_nop 0
  buffer_load_dwordx4 v55, s[12:15], s39 offen lds
  s_add_u32 m0, s41, 30720
  s_nop 0
  buffer_load_dwordx4 v56, s[12:15], s39 offen lds
  s_add_u32 m0, s41, 31744
  s_nop 0
  buffer_load_dwordx4 v57, s[12:15], s39 offen lds
  s_add_u32 s38, s38, 128
  s_add_u32 s39, s39, 524288
  s_add_u32 m0, s40, 90112
  s_nop 0
  buffer_load_dwordx4 v44, s[8:11], s38 offen lds
  s_add_u32 m0, s40, 91136
  s_nop 0
  buffer_load_dwordx4 v45, s[8:11], s38 offen lds
  s_add_u32 m0, s40, 92160
  s_nop 0
  buffer_load_dwordx4 v46, s[8:11], s38 offen lds
  s_add_u32 m0, s40, 93184
  s_nop 0
  buffer_load_dwordx4 v47, s[8:11], s38 offen lds
  s_add_u32 m0, s40, 94208
  s_nop 0
  buffer_load_dwordx4 v48, s[8:11], s38 offen lds
  s_add_u32 m0, s40, 95232
  s_nop 0
  buffer_load_dwordx4 v49, s[8:11], s38 offen lds
  s_add_u32 m0, s41, 57344
  s_nop 0
  buffer_load_dwordx4 v50, s[12:15], s39 offen lds
  s_add_u32 m0, s41, 58368
  s_nop 0
  buffer_load_dwordx4 v51, s[12:15], s39 offen lds
  s_add_u32 m0, s41, 59392
  s_nop 0
  buffer_load_dwordx4 v52, s[12:15], s39 offen lds
  s_add_u32 m0, s41, 60416
  s_nop 0
  buffer_load_dwordx4 v53, s[12:15], s39 offen lds
  s_add_u32 m0, s41, 61440
  s_nop 0
  buffer_load_dwordx4 v54, s[12:15], s39 offen lds
  s_add_u32 m0, s41, 62464
  s_nop 0
  buffer_load_dwordx4 v55, s[12:15], s39 offen lds
  s_add_u32 m0, s41, 63488
  s_nop 0
  buffer_load_dwordx4 v56, s[12:15], s39 offen lds
  s_add_u32 m0, s41, 64512
  s_nop 0
  buffer_load_dwordx4 v57, s[12:15], s39 offen lds
  s_add_u32 s38, s38, 128
  s_add_u32 s39, s39, 524288
  v_lshlrev_b32 v31, 7, v0
  s_cmp_eq_u32 s30, 0
  s_cselect_b32 s96, s16, s20
  s_cselect_b32 s97, s17, s21
  s_mov_b32 s98, 131072
  s_mov_b32 s99, 0x20000
  s_and_b32 s31, s6, 3
  s_mul_i32 s31, s31, 49152
  s_lshl_b32 s51, s28, 14
  s_add_u32 s31, s31, s51
  v_lshlrev_b32 v25, 7, v0
  buffer_load_dword v58, v25, s[8:11], s31 offen
  s_add_u32 s31, s31, 8192
  buffer_load_dword v59, v25, s[8:11], s31 offen
  v_lshrrev_b32 v26, 2, v0
  v_and_b32 v25, 3, v0
  v_lshlrev_b32 v25, 7, v25
  v_lshl_add_u32 v25, v26, 13, v25
  s_lshl_b32 s31, s5, 19
  s_lshl_b32 s51, s28, 17
  s_add_u32 s31, s31, s51
  s_lshl_b32 s51, s6, 9
  s_add_u32 s31, s31, s51
  buffer_load_dword v60, v25, s[12:15], s31 offen
  v_and_b32 v25, 31, v0
  v_lshrrev_b32 v26, 5, v0
  v_bfe_u32 v27, v25, 1, 3
  v_xor_b32 v27, v27, v26
  v_lshlrev_b32 v27, 4, v27
  v_lshl_add_u32 v27, v25, 7, v27
  s_mul_i32 s31, s30, 12288
  v_add_u32 v32, s31, v27
  v_xor_b32 v33, 32, v32
  v_xor_b32 v34, 64, v32
  v_xor_b32 v35, 96, v32
  v_add_u32 v36, 90112, v32
  v_add_u32 v37, 90112, v33
  v_add_u32 v38, 90112, v34
  v_add_u32 v39, 90112, v35
  v_and_b32 v27, 19, v25
  v_bfe_u32 v28, v25, 2, 1
  v_lshl_or_b32 v27, v28, 3, v27
  v_bfe_u32 v28, v25, 3, 1
  v_lshl_or_b32 v27, v28, 2, v27
  v_and_b32 v28, 15, v27
  v_xor_b32 v28, v28, v26
  v_lshlrev_b32 v28, 4, v28
  v_lshl_add_u32 v28, v27, 8, v28
  s_lshl_b32 s31, s29, 13
  s_add_u32 s31, s31, 114688
  v_add_u32 v2, s31, v28
  v_xor_b32 v3, 32, v2
  v_xor_b32 v4, 64, v2
  v_xor_b32 v5, 96, v2
  v_xor_b32 v6, 128, v2
  v_xor_b32 v7, 160, v2
  v_xor_b32 v8, 192, v2
  v_xor_b32 v9, 224, v2
  v_bfe_u32 v27, v0, 2, 2
  v_lshl_add_u32 v28, v26, 3, v27
  v_lshlrev_b32 v28, 8, v28
  v_lshl_or_b32 v28, v27, 6, v28
  v_bfe_u32 v29, v0, 4, 1
  v_lshl_or_b32 v28, v29, 5, v28
  v_and_b32 v29, 1, v0
  v_lshl_or_b32 v28, v29, 4, v28
  v_bfe_u32 v29, v0, 1, 1
  v_lshl_or_b32 v28, v29, 3, v28
  s_lshl_b32 s31, s29, 14
  s_add_u32 s51, s31, 24576
  s_add_u32 s31, s31, 131072
  v_xor_b32 v29, 0, v28
  v_add_u32 v40, s51, v29
  v_add_u32 v10, s31, v29
  v_xor_b32 v29, 64, v28
  v_add_u32 v41, s51, v29
  v_add_u32 v11, s31, v29
  v_xor_b32 v29, 128, v28
  v_add_u32 v42, s51, v29
  v_add_u32 v12, s31, v29
  v_xor_b32 v29, 192, v28
  v_add_u32 v43, s51, v29
  v_add_u32 v13, s31, v29
  s_mov_b32 s32, 0xff800000
  s_mov_b32 s33, 0xff800000
  s_mov_b32 s34, 0xff800000
  s_mov_b32 s35, 0xff800000
  s_mov_b32 s36, 0xff800000
  s_mov_b32 s37, 0xff800000
  s_lshl_b32 s31, s29, 13
  s_lshl_b32 s43, s30, 12
  s_add_u32 s31, s31, s43
  s_add_u32 s44, s31, 106496
  s_mov_b32 s42, s43
  s_add_u32 s51, s50, 131072
  s_waitcnt vmcnt(17)
  s_barrier
  ds_read_b128 a[208:211], v32 offset:0
  ds_read_b64_tr_b16 a[192:193], v40 offset:0
  ds_read_b64_tr_b16 a[194:195], v40 offset:1024
  ds_read_b128 a[212:215], v32 offset:4096
  ds_read_b128 a[216:219], v32 offset:8192
  ds_read_b64_tr_b16 a[196:197], v41 offset:0
  ds_read_b64_tr_b16 a[198:199], v41 offset:1024
  ds_read_b64_tr_b16 a[200:201], v42 offset:0
  ds_read_b64_tr_b16 a[202:203], v42 offset:1024
  ds_read_b64_tr_b16 a[204:205], v43 offset:0
  ds_read_b64_tr_b16 a[206:207], v43 offset:1024
  s_waitcnt lgkmcnt(0)
  v_mfma_f32_32x32x16_bf16 v[64:79], a[192:195], a[208:211], 0
  ds_read_b128 a[236:239], v33 offset:0
  ds_read_b64_tr_b16 a[220:221], v40 offset:4096
  v_mfma_f32_32x32x16_bf16 v[128:143], a[192:195], a[212:215], 0
  ds_read_b64_tr_b16 a[222:223], v40 offset:5120
  ds_read_b128 a[240:243], v33 offset:4096
  v_mfma_f32_32x32x16_bf16 v[192:207], a[192:195], a[216:219], 0
  ds_read_b128 a[244:247], v33 offset:8192
  ds_read_b64_tr_b16 a[224:225], v41 offset:4096
  v_mfma_f32_32x32x16_bf16 v[80:95], a[196:199], a[208:211], 0
  ds_read_b64_tr_b16 a[226:227], v41 offset:5120
  ds_read_b64_tr_b16 a[228:229], v42 offset:4096
  v_mfma_f32_32x32x16_bf16 v[144:159], a[196:199], a[212:215], 0
  ds_read_b64_tr_b16 a[230:231], v42 offset:5120
  ds_read_b64_tr_b16 a[232:233], v43 offset:4096
  v_mfma_f32_32x32x16_bf16 v[208:223], a[196:199], a[216:219], 0
  ds_read_b64_tr_b16 a[234:235], v43 offset:5120
  v_mfma_f32_32x32x16_bf16 v[96:111], a[200:203], a[208:211], 0
  v_mfma_f32_32x32x16_bf16 v[160:175], a[200:203], a[212:215], 0
  v_mfma_f32_32x32x16_bf16 v[224:239], a[200:203], a[216:219], 0
  v_mfma_f32_32x32x16_bf16 v[112:127], a[204:207], a[208:211], 0
  v_mfma_f32_32x32x16_bf16 v[176:191], a[204:207], a[212:215], 0
  v_mfma_f32_32x32x16_bf16 v[240:255], a[204:207], a[216:219], 0
  s_waitcnt lgkmcnt(0)
  v_mfma_f32_32x32x16_bf16 v[64:79], a[220:223], a[236:239], v[64:79]
  ds_read_b128 a[208:211], v34 offset:0
  ds_read_b64_tr_b16 a[192:193], v40 offset:8192
  v_mfma_f32_32x32x16_bf16 v[128:143], a[220:223], a[240:243], v[128:143]
  ds_read_b64_tr_b16 a[194:195], v40 offset:9216
  ds_read_b128 a[212:215], v34 offset:4096
  v_mfma_f32_32x32x16_bf16 v[192:207], a[220:223], a[244:247], v[192:207]
  ds_read_b128 a[216:219], v34 offset:8192
  ds_read_b64_tr_b16 a[196:197], v41 offset:8192
  v_mfma_f32_32x32x16_bf16 v[80:95], a[224:227], a[236:239], v[80:95]
  ds_read_b64_tr_b16 a[198:199], v41 offset:9216
  ds_read_b64_tr_b16 a[200:201], v42 offset:8192
  v_mfma_f32_32x32x16_bf16 v[144:159], a[224:227], a[240:243], v[144:159]
  ds_read_b64_tr_b16 a[202:203], v42 offset:9216
  ds_read_b64_tr_b16 a[204:205], v43 offset:8192
  v_mfma_f32_32x32x16_bf16 v[208:223], a[224:227], a[244:247], v[208:223]
  ds_read_b64_tr_b16 a[206:207], v43 offset:9216
  v_mfma_f32_32x32x16_bf16 v[96:111], a[228:231], a[236:239], v[96:111]
  v_mfma_f32_32x32x16_bf16 v[160:175], a[228:231], a[240:243], v[160:175]
  v_mfma_f32_32x32x16_bf16 v[224:239], a[228:231], a[244:247], v[224:239]
  v_mfma_f32_32x32x16_bf16 v[112:127], a[232:235], a[236:239], v[112:127]
  v_mfma_f32_32x32x16_bf16 v[176:191], a[232:235], a[240:243], v[176:191]
  v_mfma_f32_32x32x16_bf16 v[240:255], a[232:235], a[244:247], v[240:255]
  s_waitcnt lgkmcnt(0)
  v_mfma_f32_32x32x16_bf16 v[64:79], a[192:195], a[208:211], v[64:79]
  ds_read_b128 a[236:239], v35 offset:0
  ds_read_b64_tr_b16 a[220:221], v40 offset:12288
  v_mfma_f32_32x32x16_bf16 v[128:143], a[192:195], a[212:215], v[128:143]
  ds_read_b64_tr_b16 a[222:223], v40 offset:13312
  ds_read_b128 a[240:243], v35 offset:4096
  v_mfma_f32_32x32x16_bf16 v[192:207], a[192:195], a[216:219], v[192:207]
  ds_read_b128 a[244:247], v35 offset:8192
  ds_read_b64_tr_b16 a[224:225], v41 offset:12288
  v_mfma_f32_32x32x16_bf16 v[80:95], a[196:199], a[208:211], v[80:95]
  ds_read_b64_tr_b16 a[226:227], v41 offset:13312
  ds_read_b64_tr_b16 a[228:229], v42 offset:12288
  v_mfma_f32_32x32x16_bf16 v[144:159], a[196:199], a[212:215], v[144:159]
  ds_read_b64_tr_b16 a[230:231], v42 offset:13312
  ds_read_b64_tr_b16 a[232:233], v43 offset:12288
  v_mfma_f32_32x32x16_bf16 v[208:223], a[196:199], a[216:219], v[208:223]
  ds_read_b64_tr_b16 a[234:235], v43 offset:13312
  v_mfma_f32_32x32x16_bf16 v[96:111], a[200:203], a[208:211], v[96:111]
  v_mfma_f32_32x32x16_bf16 v[160:175], a[200:203], a[212:215], v[160:175]
  v_mfma_f32_32x32x16_bf16 v[224:239], a[200:203], a[216:219], v[224:239]
  v_mfma_f32_32x32x16_bf16 v[112:127], a[204:207], a[208:211], v[112:127]
  v_mfma_f32_32x32x16_bf16 v[176:191], a[204:207], a[212:215], v[176:191]
  v_mfma_f32_32x32x16_bf16 v[240:255], a[204:207], a[216:219], v[240:255]
  s_waitcnt lgkmcnt(0)
  s_waitcnt vmcnt(3)
  s_barrier
  v_mfma_f32_32x32x16_bf16 v[64:79], a[220:223], a[236:239], v[64:79]
  ds_read_b128 a[208:211], v36 offset:0
  ds_read_b64_tr_b16 a[192:193], v40 offset:32768
  v_mfma_f32_32x32x16_bf16 v[128:143], a[220:223], a[240:243], v[128:143]
  ds_read_b64_tr_b16 a[194:195], v40 offset:33792
  ds_read_b128 a[212:215], v36 offset:4096
  s_add_u32 m0, s40, 0
  s_nop 0
  buffer_load_dwordx4 v44, s[8:11], s38 offen lds
  v_mfma_f32_32x32x16_bf16 v[192:207], a[220:223], a[244:247], v[192:207]
  ds_read_b128 a[216:219], v36 offset:8192
  ds_read_b64_tr_b16 a[196:197], v41 offset:32768
  v_mfma_f32_32x32x16_bf16 v[80:95], a[224:227], a[236:239], v[80:95]
  ds_read_b64_tr_b16 a[198:199], v41 offset:33792
  ds_read_b64_tr_b16 a[200:201], v42 offset:32768
  s_add_u32 m0, s40, 1024
  s_nop 0
  buffer_load_dwordx4 v45, s[8:11], s38 offen lds
  v_mfma_f32_32x32x16_bf16 v[144:159], a[224:227], a[240:243], v[144:159]
  ds_read_b64_tr_b16 a[202:203], v42 offset:33792
  ds_read_b64_tr_b16 a[204:205], v43 offset:32768
  v_mfma_f32_32x32x16_bf16 v[208:223], a[224:227], a[244:247], v[208:223]
  ds_read_b64_tr_b16 a[206:207], v43 offset:33792
  s_add_u32 m0, s40, 2048
  s_nop 0
  buffer_load_dwordx4 v46, s[8:11], s38 offen lds
  v_mfma_f32_32x32x16_bf16 v[96:111], a[228:231], a[236:239], v[96:111]
  v_mfma_f32_32x32x16_bf16 v[160:175], a[228:231], a[240:243], v[160:175]
  s_add_u32 m0, s40, 3072
  s_nop 0
  buffer_load_dwordx4 v47, s[8:11], s38 offen lds
  v_mfma_f32_32x32x16_bf16 v[224:239], a[228:231], a[244:247], v[224:239]
  v_mfma_f32_32x32x16_bf16 v[112:127], a[232:235], a[236:239], v[112:127]
  s_add_u32 m0, s40, 4096
  s_nop 0
  buffer_load_dwordx4 v48, s[8:11], s38 offen lds
  v_mfma_f32_32x32x16_bf16 v[176:191], a[232:235], a[240:243], v[176:191]
  v_mfma_f32_32x32x16_bf16 v[240:255], a[232:235], a[244:247], v[240:255]
  s_add_u32 m0, s40, 5120
  s_nop 0
  buffer_load_dwordx4 v49, s[8:11], s38 offen lds
  s_waitcnt lgkmcnt(0)
  v_mfma_f32_32x32x16_bf16 v[64:79], a[192:195], a[208:211], v[64:79]
  ds_read_b128 a[236:239], v37 offset:0
  ds_read_b64_tr_b16 a[220:221], v40 offset:36864
  v_mfma_f32_32x32x16_bf16 v[128:143], a[192:195], a[212:215], v[128:143]
  ds_read_b64_tr_b16 a[222:223], v40 offset:37888
  ds_read_b128 a[240:243], v37 offset:4096
  s_add_u32 m0, s41, 24576
  s_nop 0
  buffer_load_dwordx4 v50, s[12:15], s39 offen lds
  v_mfma_f32_32x32x16_bf16 v[192:207], a[192:195], a[216:219], v[192:207]
  ds_read_b128 a[244:247], v37 offset:8192
  ds_read_b64_tr_b16 a[224:225], v41 offset:36864
  v_mfma_f32_32x32x16_bf16 v[80:95], a[196:199], a[208:211], v[80:95]
  ds_read_b64_tr_b16 a[226:227], v41 offset:37888
  ds_read_b64_tr_b16 a[228:229], v42 offset:36864
  s_add_u32 m0, s41, 25600
  s_nop 0
  buffer_load_dwordx4 v51, s[12:15], s39 offen lds
  v_mfma_f32_32x32x16_bf16 v[144:159], a[196:199], a[212:215], v[144:159]
  ds_read_b64_tr_b16 a[230:231], v42 offset:37888
  ds_read_b64_tr_b16 a[232:233], v43 offset:36864
  v_mfma_f32_32x32x16_bf16 v[208:223], a[196:199], a[216:219], v[208:223]
  ds_read_b64_tr_b16 a[234:235], v43 offset:37888
  v_mfma_f32_32x32x16_bf16 v[96:111], a[200:203], a[208:211], v[96:111]
  s_add_u32 m0, s41, 26624
  s_nop 0
  buffer_load_dwordx4 v52, s[12:15], s39 offen lds
  v_mfma_f32_32x32x16_bf16 v[160:175], a[200:203], a[212:215], v[160:175]
  v_mfma_f32_32x32x16_bf16 v[224:239], a[200:203], a[216:219], v[224:239]
  s_add_u32 m0, s41, 27648
  s_nop 0
  buffer_load_dwordx4 v53, s[12:15], s39 offen lds
  v_mfma_f32_32x32x16_bf16 v[112:127], a[204:207], a[208:211], v[112:127]
  v_mfma_f32_32x32x16_bf16 v[176:191], a[204:207], a[212:215], v[176:191]
  s_add_u32 m0, s41, 28672
  s_nop 0
  buffer_load_dwordx4 v54, s[12:15], s39 offen lds
  v_mfma_f32_32x32x16_bf16 v[240:255], a[204:207], a[216:219], v[240:255]
  s_waitcnt lgkmcnt(0)
  v_mfma_f32_32x32x16_bf16 v[64:79], a[220:223], a[236:239], v[64:79]
  ds_read_b128 a[208:211], v38 offset:0
  ds_read_b64_tr_b16 a[192:193], v40 offset:40960
  v_mfma_f32_32x32x16_bf16 v[128:143], a[220:223], a[240:243], v[128:143]
  ds_read_b64_tr_b16 a[194:195], v40 offset:41984
  ds_read_b128 a[212:215], v38 offset:4096
  s_add_u32 m0, s41, 29696
  s_nop 0
  buffer_load_dwordx4 v55, s[12:15], s39 offen lds
  v_mfma_f32_32x32x16_bf16 v[192:207], a[220:223], a[244:247], v[192:207]
  ds_read_b128 a[216:219], v38 offset:8192
  ds_read_b64_tr_b16 a[196:197], v41 offset:40960
  v_mfma_f32_32x32x16_bf16 v[80:95], a[224:227], a[236:239], v[80:95]
  ds_read_b64_tr_b16 a[198:199], v41 offset:41984
  ds_read_b64_tr_b16 a[200:201], v42 offset:40960
  v_mfma_f32_32x32x16_bf16 v[144:159], a[224:227], a[240:243], v[144:159]
  ds_read_b64_tr_b16 a[202:203], v42 offset:41984
  ds_read_b64_tr_b16 a[204:205], v43 offset:40960
  s_add_u32 m0, s41, 30720
  s_nop 0
  buffer_load_dwordx4 v56, s[12:15], s39 offen lds
  v_mfma_f32_32x32x16_bf16 v[208:223], a[224:227], a[244:247], v[208:223]
  ds_read_b64_tr_b16 a[206:207], v43 offset:41984
  v_mfma_f32_32x32x16_bf16 v[96:111], a[228:231], a[236:239], v[96:111]
  v_mfma_f32_32x32x16_bf16 v[160:175], a[228:231], a[240:243], v[160:175]
  s_add_u32 m0, s41, 31744
  s_nop 0
  buffer_load_dwordx4 v57, s[12:15], s39 offen lds
  v_mfma_f32_32x32x16_bf16 v[224:239], a[228:231], a[244:247], v[224:239]
  v_mfma_f32_32x32x16_bf16 v[112:127], a[232:235], a[236:239], v[112:127]
  s_add_u32 s38, s38, 128
  s_add_u32 s39, s39, 524288
  v_mfma_f32_32x32x16_bf16 v[176:191], a[232:235], a[240:243], v[176:191]
  v_mfma_f32_32x32x16_bf16 v[240:255], a[232:235], a[244:247], v[240:255]
  s_waitcnt lgkmcnt(0)
  v_mfma_f32_32x32x16_bf16 v[64:79], a[192:195], a[208:211], v[64:79]
  ds_read_b128 a[236:239], v39 offset:0
  ds_read_b64_tr_b16 a[220:221], v40 offset:45056
  s_add_u32 m0, s44, 8192
  s_nop 0
  buffer_load_dwordx4 v14, s[16:19], s43 offen nt lds
  v_mfma_f32_32x32x16_bf16 v[128:143], a[192:195], a[212:215], v[128:143]
  ds_read_b64_tr_b16 a[222:223], v40 offset:46080
  ds_read_b128 a[240:243], v39 offset:4096
  buffer_load_dwordx4 v15, s[16:19], s43 offen offset:1024 nt lds
  v_mfma_f32_32x32x16_bf16 v[192:207], a[192:195], a[216:219], v[192:207]
  ds_read_b128 a[244:247], v39 offset:8192
  ds_read_b64_tr_b16 a[224:225], v41 offset:45056
  buffer_load_dwordx4 v16, s[16:19], s43 offen offset:2048 nt lds
  v_mfma_f32_32x32x16_bf16 v[80:95], a[196:199], a[208:211], v[80:95]
  ds_read_b64_tr_b16 a[226:227], v41 offset:46080
  ds_read_b64_tr_b16 a[228:229], v42 offset:45056
  buffer_load_dwordx4 v17, s[16:19], s43 offen offset:3072 nt lds
  s_add_u32 s43, s43, 8192
  s_cmp_ge_u32 s43, 131072
  s_cselect_b32 s18, 0, 131072
  v_mfma_f32_32x32x16_bf16 v[144:159], a[196:199], a[212:215], v[144:159]
  ds_read_b64_tr_b16 a[230:231], v42 offset:46080
  ds_read_b64_tr_b16 a[232:233], v43 offset:45056
  v_mfma_f32_32x32x16_bf16 v[208:223], a[196:199], a[216:219], v[208:223]
  ds_read_b64_tr_b16 a[234:235], v43 offset:46080
  v_mfma_f32_32x32x16_bf16 v[96:111], a[200:203], a[208:211], v[96:111]
  v_mfma_f32_32x32x16_bf16 v[160:175], a[200:203], a[212:215], v[160:175]
  v_mfma_f32_32x32x16_bf16 v[224:239], a[200:203], a[216:219], v[224:239]
  v_mfma_f32_32x32x16_bf16 v[112:127], a[204:207], a[208:211], v[112:127]
  v_mfma_f32_32x32x16_bf16 v[176:191], a[204:207], a[212:215], v[176:191]
  v_mfma_f32_32x32x16_bf16 v[240:255], a[204:207], a[216:219], v[240:255]
  s_waitcnt lgkmcnt(0)
  s_waitcnt vmcnt(4)
  s_barrier
  v_mfma_f32_32x32x16_bf16 v[64:79], a[220:223], a[236:239], v[64:79]
  ds_read_b128 a[208:211], v32 offset:0
  ds_read_b64_tr_b16 a[192:193], v40 offset:0
  v_mfma_f32_32x32x16_bf16 v[128:143], a[220:223], a[240:243], v[128:143]
  ds_read_b64_tr_b16 a[194:195], v40 offset:1024
  ds_read_b128 a[212:215], v32 offset:4096
  s_add_u32 m0, s40, 90112
  s_nop 0
  buffer_load_dwordx4 v44, s[8:11], s38 offen lds
  v_mfma_f32_32x32x16_bf16 v[192:207], a[220:223], a[244:247], v[192:207]
  ds_read_b128 a[216:219], v32 offset:8192
  ds_read_b64_tr_b16 a[196:197], v41 offset:0
  v_mfma_f32_32x32x16_bf16 v[80:95], a[224:227], a[236:239], v[80:95]
  ds_read_b64_tr_b16 a[198:199], v41 offset:1024
  ds_read_b64_tr_b16 a[200:201], v42 offset:0
  s_add_u32 m0, s40, 91136
  s_nop 0
  buffer_load_dwordx4 v45, s[8:11], s38 offen lds
  v_mfma_f32_32x32x16_bf16 v[144:159], a[224:227], a[240:243], v[144:159]
  ds_read_b64_tr_b16 a[202:203], v42 offset:1024
  ds_read_b64_tr_b16 a[204:205], v43 offset:0
  v_mfma_f32_32x32x16_bf16 v[208:223], a[224:227], a[244:247], v[208:223]
  ds_read_b64_tr_b16 a[206:207], v43 offset:1024
  s_add_u32 m0, s40, 92160
  s_nop 0
  buffer_load_dwordx4 v46, s[8:11], s38 offen lds
  v_mfma_f32_32x32x16_bf16 v[96:111], a[228:231], a[236:239], v[96:111]
  v_mfma_f32_32x32x16_bf16 v[160:175], a[228:231], a[240:243], v[160:175]
  s_add_u32 m0, s40, 93184
  s_nop 0
  buffer_load_dwordx4 v47, s[8:11], s38 offen lds
  v_mfma_f32_32x32x16_bf16 v[224:239], a[228:231], a[244:247], v[224:239]
  v_mfma_f32_32x32x16_bf16 v[112:127], a[232:235], a[236:239], v[112:127]
  s_add_u32 m0, s40, 94208
  s_nop 0
  buffer_load_dwordx4 v48, s[8:11], s38 offen lds
  v_mfma_f32_32x32x16_bf16 v[176:191], a[232:235], a[240:243], v[176:191]
  v_mfma_f32_32x32x16_bf16 v[240:255], a[232:235], a[244:247], v[240:255]
  s_add_u32 m0, s40, 95232
  s_nop 0
  buffer_load_dwordx4 v49, s[8:11], s38 offen lds
  s_waitcnt lgkmcnt(0)
  v_mfma_f32_32x32x16_bf16 v[64:79], a[192:195], a[208:211], v[64:79]
  ds_read_b128 a[236:239], v33 offset:0
  ds_read_b64_tr_b16 a[220:221], v40 offset:4096
  v_mfma_f32_32x32x16_bf16 v[128:143], a[192:195], a[212:215], v[128:143]
  ds_read_b64_tr_b16 a[222:223], v40 offset:5120
  ds_read_b128 a[240:243], v33 offset:4096
  s_add_u32 m0, s41, 57344
  s_nop 0
  buffer_load_dwordx4 v50, s[12:15], s39 offen lds
  v_mfma_f32_32x32x16_bf16 v[192:207], a[192:195], a[216:219], v[192:207]
  ds_read_b128 a[244:247], v33 offset:8192
  ds_read_b64_tr_b16 a[224:225], v41 offset:4096
  v_mfma_f32_32x32x16_bf16 v[80:95], a[196:199], a[208:211], v[80:95]
  ds_read_b64_tr_b16 a[226:227], v41 offset:5120
  ds_read_b64_tr_b16 a[228:229], v42 offset:4096
  s_add_u32 m0, s41, 58368
  s_nop 0
  buffer_load_dwordx4 v51, s[12:15], s39 offen lds
  v_mfma_f32_32x32x16_bf16 v[144:159], a[196:199], a[212:215], v[144:159]
  ds_read_b64_tr_b16 a[230:231], v42 offset:5120
  ds_read_b64_tr_b16 a[232:233], v43 offset:4096
  v_mfma_f32_32x32x16_bf16 v[208:223], a[196:199], a[216:219], v[208:223]
  ds_read_b64_tr_b16 a[234:235], v43 offset:5120
  v_mfma_f32_32x32x16_bf16 v[96:111], a[200:203], a[208:211], v[96:111]
  s_add_u32 m0, s41, 59392
  s_nop 0
  buffer_load_dwordx4 v52, s[12:15], s39 offen lds
  v_mfma_f32_32x32x16_bf16 v[160:175], a[200:203], a[212:215], v[160:175]
  v_accvgpr_write_b32 a0, 0
  v_accvgpr_write_b32 a1, 0
  v_accvgpr_write_b32 a2, 0
  v_accvgpr_write_b32 a3, 0
  v_mfma_f32_32x32x16_bf16 v[224:239], a[200:203], a[216:219], v[224:239]
  s_add_u32 m0, s41, 60416
  s_nop 0
  buffer_load_dwordx4 v53, s[12:15], s39 offen lds
  v_mfma_f32_32x32x16_bf16 v[112:127], a[204:207], a[208:211], v[112:127]
  v_accvgpr_write_b32 a4, 0
  v_accvgpr_write_b32 a5, 0
  v_accvgpr_write_b32 a6, 0
  v_accvgpr_write_b32 a7, 0
  v_mfma_f32_32x32x16_bf16 v[176:191], a[204:207], a[212:215], v[176:191]
  s_add_u32 m0, s41, 61440
  s_nop 0
  buffer_load_dwordx4 v54, s[12:15], s39 offen lds
  v_mfma_f32_32x32x16_bf16 v[240:255], a[204:207], a[216:219], v[240:255]
  v_accvgpr_write_b32 a8, 0
  v_accvgpr_write_b32 a9, 0
  v_accvgpr_write_b32 a10, 0
  v_accvgpr_write_b32 a11, 0
  s_waitcnt lgkmcnt(0)
  v_mfma_f32_32x32x16_bf16 v[64:79], a[220:223], a[236:239], v[64:79]
  ds_read_b128 a[208:211], v34 offset:0
  ds_read_b64_tr_b16 a[192:193], v40 offset:8192
  v_mfma_f32_32x32x16_bf16 v[128:143], a[220:223], a[240:243], v[128:143]
  ds_read_b64_tr_b16 a[194:195], v40 offset:9216
  ds_read_b128 a[212:215], v34 offset:4096
  s_add_u32 m0, s41, 62464
  s_nop 0
  buffer_load_dwordx4 v55, s[12:15], s39 offen lds
  v_mfma_f32_32x32x16_bf16 v[192:207], a[220:223], a[244:247], v[192:207]
  ds_read_b128 a[216:219], v34 offset:8192
  ds_read_b64_tr_b16 a[196:197], v41 offset:8192
  v_mfma_f32_32x32x16_bf16 v[80:95], a[224:227], a[236:239], v[80:95]
  ds_read_b64_tr_b16 a[198:199], v41 offset:9216
  ds_read_b64_tr_b16 a[200:201], v42 offset:8192
  v_mfma_f32_32x32x16_bf16 v[144:159], a[224:227], a[240:243], v[144:159]
  ds_read_b64_tr_b16 a[202:203], v42 offset:9216
  ds_read_b64_tr_b16 a[204:205], v43 offset:8192
  s_add_u32 m0, s41, 63488
  s_nop 0
  buffer_load_dwordx4 v56, s[12:15], s39 offen lds
  v_mfma_f32_32x32x16_bf16 v[208:223], a[224:227], a[244:247], v[208:223]
  ds_read_b64_tr_b16 a[206:207], v43 offset:9216
  v_mfma_f32_32x32x16_bf16 v[96:111], a[228:231], a[236:239], v[96:111]
  v_accvgpr_write_b32 a12, 0
  v_accvgpr_write_b32 a13, 0
  v_accvgpr_write_b32 a14, 0
  v_accvgpr_write_b32 a15, 0
  v_mfma_f32_32x32x16_bf16 v[160:175], a[228:231], a[240:243], v[160:175]
  s_add_u32 m0, s41, 64512
  s_nop 0
  buffer_load_dwordx4 v57, s[12:15], s39 offen lds
  v_mfma_f32_32x32x16_bf16 v[224:239], a[228:231], a[244:247], v[224:239]
  v_accvgpr_write_b32 a16, 0
  v_accvgpr_write_b32 a17, 0
  v_accvgpr_write_b32 a18, 0
  v_accvgpr_write_b32 a19, 0
  v_mfma_f32_32x32x16_bf16 v[112:127], a[232:235], a[236:239], v[112:127]
  s_add_u32 s38, s38, 128
  s_add_u32 s39, s39, 524288
  v_mfma_f32_32x32x16_bf16 v[176:191], a[232:235], a[240:243], v[176:191]
  v_accvgpr_write_b32 a20, 0
  v_accvgpr_write_b32 a21, 0
  v_accvgpr_write_b32 a22, 0
  v_accvgpr_write_b32 a23, 0
  v_mfma_f32_32x32x16_bf16 v[240:255], a[232:235], a[244:247], v[240:255]
  v_accvgpr_write_b32 a24, 0
  v_accvgpr_write_b32 a25, 0
  v_accvgpr_write_b32 a26, 0
  v_accvgpr_write_b32 a27, 0
  s_waitcnt lgkmcnt(0)
  v_mfma_f32_32x32x16_bf16 v[64:79], a[192:195], a[208:211], v[64:79]
  ds_read_b128 a[236:239], v35 offset:0
  ds_read_b64_tr_b16 a[220:221], v40 offset:12288
  v_mfma_f32_32x32x16_bf16 v[128:143], a[192:195], a[212:215], v[128:143]
  ds_read_b64_tr_b16 a[222:223], v40 offset:13312
  ds_read_b128 a[240:243], v35 offset:4096
  v_mfma_f32_32x32x16_bf16 v[192:207], a[192:195], a[216:219], v[192:207]
  ds_read_b128 a[244:247], v35 offset:8192
  ds_read_b64_tr_b16 a[224:225], v41 offset:12288
  v_mfma_f32_32x32x16_bf16 v[80:95], a[196:199], a[208:211], v[80:95]
  ds_read_b64_tr_b16 a[226:227], v41 offset:13312
  ds_read_b64_tr_b16 a[228:229], v42 offset:12288
  v_mfma_f32_32x32x16_bf16 v[144:159], a[196:199], a[212:215], v[144:159]
  ds_read_b64_tr_b16 a[230:231], v42 offset:13312
  ds_read_b64_tr_b16 a[232:233], v43 offset:12288
  s_add_u32 s44, s50, 131072
  v_mfma_f32_32x32x16_bf16 v[208:223], a[196:199], a[216:219], v[208:223]
  ds_read_b64_tr_b16 a[234:235], v43 offset:13312
  s_mov_b32 m0, s44
  s_nop 0
  buffer_load_dwordx4 v18, s[20:23], s42 offen nt lds
  v_mfma_f32_32x32x16_bf16 v[96:111], a[200:203], a[208:211], v[96:111]
  buffer_load_dwordx4 v18, s[20:23], s42 offen offset:1024 nt lds
  v_mfma_f32_32x32x16_bf16 v[160:175], a[200:203], a[212:215], v[160:175]
  buffer_load_dwordx4 v18, s[20:23], s42 offen offset:2048 nt lds
  v_mfma_f32_32x32x16_bf16 v[224:239], a[200:203], a[216:219], v[224:239]
  buffer_load_dwordx4 v18, s[20:23], s42 offen offset:3072 nt lds
  s_add_u32 s42, s42, 8192
  s_cmp_ge_u32 s42, 131072
  s_cselect_b32 s22, 0, 131072
  v_mfma_f32_32x32x16_bf16 v[112:127], a[204:207], a[208:211], v[112:127]
  v_accvgpr_write_b32 a28, 0
  v_accvgpr_write_b32 a29, 0
  v_accvgpr_write_b32 a30, 0
  v_accvgpr_write_b32 a31, 0
  v_mfma_f32_32x32x16_bf16 v[176:191], a[204:207], a[212:215], v[176:191]
  v_accvgpr_write_b32 a32, 0
  v_accvgpr_write_b32 a33, 0
  v_accvgpr_write_b32 a34, 0
  v_accvgpr_write_b32 a35, 0
  v_mfma_f32_32x32x16_bf16 v[240:255], a[204:207], a[216:219], v[240:255]
  v_accvgpr_write_b32 a36, 0
  v_accvgpr_write_b32 a37, 0
  v_accvgpr_write_b32 a38, 0
  v_accvgpr_write_b32 a39, 0
  s_waitcnt lgkmcnt(0)
  s_waitcnt vmcnt(4)
  s_barrier
  v_mfma_f32_32x32x16_bf16 v[64:79], a[220:223], a[236:239], v[64:79]
  ds_read_b128 a[208:211], v36 offset:0
  ds_read_b64_tr_b16 a[192:193], v40 offset:32768
  v_mfma_f32_32x32x16_bf16 v[128:143], a[220:223], a[240:243], v[128:143]
  ds_read_b64_tr_b16 a[194:195], v40 offset:33792
  ds_read_b128 a[212:215], v36 offset:4096
  s_add_u32 m0, s40, 0
  s_nop 0
  buffer_load_dwordx4 v44, s[8:11], s38 offen lds
  v_mfma_f32_32x32x16_bf16 v[192:207], a[220:223], a[244:247], v[192:207]
  ds_read_b128 a[216:219], v36 offset:8192
  ds_read_b64_tr_b16 a[196:197], v41 offset:32768
  v_mfma_f32_32x32x16_bf16 v[80:95], a[224:227], a[236:239], v[80:95]
  ds_read_b64_tr_b16 a[198:199], v41 offset:33792
  ds_read_b64_tr_b16 a[200:201], v42 offset:32768
  s_add_u32 m0, s40, 1024
  s_nop 0
  buffer_load_dwordx4 v45, s[8:11], s38 offen lds
  v_mfma_f32_32x32x16_bf16 v[144:159], a[224:227], a[240:243], v[144:159]
  ds_read_b64_tr_b16 a[202:203], v42 offset:33792
  ds_read_b64_tr_b16 a[204:205], v43 offset:32768
  v_mfma_f32_32x32x16_bf16 v[208:223], a[224:227], a[244:247], v[208:223]
  ds_read_b64_tr_b16 a[206:207], v43 offset:33792
  s_add_u32 m0, s40, 2048
  s_nop 0
  buffer_load_dwordx4 v46, s[8:11], s38 offen lds
  v_mfma_f32_32x32x16_bf16 v[96:111], a[228:231], a[236:239], v[96:111]
  v_accvgpr_write_b32 a40, 0
  v_accvgpr_write_b32 a41, 0
  v_accvgpr_write_b32 a42, 0
  v_accvgpr_write_b32 a43, 0
  v_mfma_f32_32x32x16_bf16 v[160:175], a[228:231], a[240:243], v[160:175]
  s_add_u32 m0, s40, 3072
  s_nop 0
  buffer_load_dwordx4 v47, s[8:11], s38 offen lds
  v_mfma_f32_32x32x16_bf16 v[224:239], a[228:231], a[244:247], v[224:239]
  v_accvgpr_write_b32 a44, 0
  v_accvgpr_write_b32 a45, 0
  v_accvgpr_write_b32 a46, 0
  v_accvgpr_write_b32 a47, 0
  v_mfma_f32_32x32x16_bf16 v[112:127], a[232:235], a[236:239], v[112:127]
  s_add_u32 m0, s40, 4096
  s_nop 0
  buffer_load_dwordx4 v48, s[8:11], s38 offen lds
  v_mfma_f32_32x32x16_bf16 v[176:191], a[232:235], a[240:243], v[176:191]
  v_accvgpr_write_b32 a48, 0
  v_accvgpr_write_b32 a49, 0
  v_accvgpr_write_b32 a50, 0
  v_accvgpr_write_b32 a51, 0
  v_mfma_f32_32x32x16_bf16 v[240:255], a[232:235], a[244:247], v[240:255]
  s_add_u32 m0, s40, 5120
  s_nop 0
  buffer_load_dwordx4 v49, s[8:11], s38 offen lds
  s_waitcnt lgkmcnt(0)
  v_mfma_f32_32x32x16_bf16 v[64:79], a[192:195], a[208:211], v[64:79]
  ds_read_b128 a[236:239], v37 offset:0
  ds_read_b64_tr_b16 a[220:221], v40 offset:36864
  v_mfma_f32_32x32x16_bf16 v[128:143], a[192:195], a[212:215], v[128:143]
  ds_read_b64_tr_b16 a[222:223], v40 offset:37888
  ds_read_b128 a[240:243], v37 offset:4096
  s_add_u32 m0, s41, 24576
  s_nop 0
  buffer_load_dwordx4 v50, s[12:15], s39 offen lds
  v_mfma_f32_32x32x16_bf16 v[192:207], a[192:195], a[216:219], v[192:207]
  ds_read_b128 a[244:247], v37 offset:8192
  ds_read_b64_tr_b16 a[224:225], v41 offset:36864
  v_mfma_f32_32x32x16_bf16 v[80:95], a[196:199], a[208:211], v[80:95]
  ds_read_b64_tr_b16 a[226:227], v41 offset:37888
  ds_read_b64_tr_b16 a[228:229], v42 offset:36864
  s_add_u32 m0, s41, 25600
  s_nop 0
  buffer_load_dwordx4 v51, s[12:15], s39 offen lds
  v_mfma_f32_32x32x16_bf16 v[144:159], a[196:199], a[212:215], v[144:159]
  ds_read_b64_tr_b16 a[230:231], v42 offset:37888
  ds_read_b64_tr_b16 a[232:233], v43 offset:36864
  v_mfma_f32_32x32x16_bf16 v[208:223], a[196:199], a[216:219], v[208:223]
  ds_read_b64_tr_b16 a[234:235], v43 offset:37888
  v_mfma_f32_32x32x16_bf16 v[96:111], a[200:203], a[208:211], v[96:111]
  s_add_u32 m0, s41, 26624
  s_nop 0
  buffer_load_dwordx4 v52, s[12:15], s39 offen lds
  v_mfma_f32_32x32x16_bf16 v[160:175], a[200:203], a[212:215], v[160:175]
  v_accvgpr_write_b32 a52, 0
  v_accvgpr_write_b32 a53, 0
  v_accvgpr_write_b32 a54, 0
  v_accvgpr_write_b32 a55, 0
  v_mfma_f32_32x32x16_bf16 v[224:239], a[200:203], a[216:219], v[224:239]
  s_add_u32 m0, s41, 27648
  s_nop 0
  buffer_load_dwordx4 v53, s[12:15], s39 offen lds
  v_mfma_f32_32x32x16_bf16 v[112:127], a[204:207], a[208:211], v[112:127]
  v_accvgpr_write_b32 a56, 0
  v_accvgpr_write_b32 a57, 0
  v_accvgpr_write_b32 a58, 0
  v_accvgpr_write_b32 a59, 0
  v_mfma_f32_32x32x16_bf16 v[176:191], a[204:207], a[212:215], v[176:191]
  s_add_u32 m0, s41, 28672
  s_nop 0
  buffer_load_dwordx4 v54, s[12:15], s39 offen lds
  v_mfma_f32_32x32x16_bf16 v[240:255], a[204:207], a[216:219], v[240:255]
  v_accvgpr_write_b32 a60, 0
  v_accvgpr_write_b32 a61, 0
  v_accvgpr_write_b32 a62, 0
  v_accvgpr_write_b32 a63, 0
  s_waitcnt lgkmcnt(0)
  v_mfma_f32_32x32x16_bf16 v[64:79], a[220:223], a[236:239], v[64:79]
  ds_read_b128 a[208:211], v38 offset:0
  ds_read_b64_tr_b16 a[192:193], v40 offset:40960
  v_mfma_f32_32x32x16_bf16 v[128:143], a[220:223], a[240:243], v[128:143]
  ds_read_b64_tr_b16 a[194:195], v40 offset:41984
  ds_read_b128 a[212:215], v38 offset:4096
  s_add_u32 m0, s41, 29696
  s_nop 0
  buffer_load_dwordx4 v55, s[12:15], s39 offen lds
  v_mfma_f32_32x32x16_bf16 v[192:207], a[220:223], a[244:247], v[192:207]
  ds_read_b128 a[216:219], v38 offset:8192
  ds_read_b64_tr_b16 a[196:197], v41 offset:40960
  v_mfma_f32_32x32x16_bf16 v[80:95], a[224:227], a[236:239], v[80:95]
  ds_read_b64_tr_b16 a[198:199], v41 offset:41984
  ds_read_b64_tr_b16 a[200:201], v42 offset:40960
  v_mfma_f32_32x32x16_bf16 v[144:159], a[224:227], a[240:243], v[144:159]
  ds_read_b64_tr_b16 a[202:203], v42 offset:41984
  ds_read_b64_tr_b16 a[204:205], v43 offset:40960
  s_add_u32 m0, s41, 30720
  s_nop 0
  buffer_load_dwordx4 v56, s[12:15], s39 offen lds
  v_mfma_f32_32x32x16_bf16 v[208:223], a[224:227], a[244:247], v[208:223]
  ds_read_b64_tr_b16 a[206:207], v43 offset:41984
  v_mfma_f32_32x32x16_bf16 v[96:111], a[228:231], a[236:239], v[96:111]
  v_accvgpr_write_b32 a64, 0
  v_accvgpr_write_b32 a65, 0
  v_accvgpr_write_b32 a66, 0
  v_accvgpr_write_b32 a67, 0
  v_mfma_f32_32x32x16_bf16 v[160:175], a[228:231], a[240:243], v[160:175]
  s_add_u32 m0, s41, 31744
  s_nop 0
  buffer_load_dwordx4 v57, s[12:15], s39 offen lds
  v_mfma_f32_32x32x16_bf16 v[224:239], a[228:231], a[244:247], v[224:239]
  v_accvgpr_write_b32 a68, 0
  v_accvgpr_write_b32 a69, 0
  v_accvgpr_write_b32 a70, 0
  v_accvgpr_write_b32 a71, 0
  v_mfma_f32_32x32x16_bf16 v[112:127], a[232:235], a[236:239], v[112:127]
  s_add_u32 s38, s38, 128
  s_add_u32 s39, s39, 524288
  v_mfma_f32_32x32x16_bf16 v[176:191], a[232:235], a[240:243], v[176:191]
  v_accvgpr_write_b32 a72, 0
  v_accvgpr_write_b32 a73, 0
  v_accvgpr_write_b32 a74, 0
  v_accvgpr_write_b32 a75, 0
  v_mfma_f32_32x32x16_bf16 v[240:255], a[232:235], a[244:247], v[240:255]
  v_accvgpr_write_b32 a76, 0
  v_accvgpr_write_b32 a77, 0
  v_accvgpr_write_b32 a78, 0
  v_accvgpr_write_b32 a79, 0
  s_waitcnt lgkmcnt(0)
  v_mfma_f32_32x32x16_bf16 v[64:79], a[192:195], a[208:211], v[64:79]
  ds_read_b128 a[236:239], v39 offset:0
  ds_read_b64_tr_b16 a[220:221], v40 offset:45056
  s_lshl_b32 s48, s30, 12
  s_add_u32 s48, s48, 8192
  buffer_load_dwordx4 a[128:131], v18, s[20:23], s48 offen nt
  v_mfma_f32_32x32x16_bf16 v[128:143], a[192:195], a[212:215], v[128:143]
  ds_read_b64_tr_b16 a[222:223], v40 offset:46080
  ds_read_b128 a[240:243], v39 offset:4096
  buffer_load_dwordx4 a[132:135], v18, s[20:23], s48 offen offset:1024 nt
  v_mfma_f32_32x32x16_bf16 v[192:207], a[192:195], a[216:219], v[192:207]
  ds_read_b128 a[244:247], v39 offset:8192
  ds_read_b64_tr_b16 a[224:225], v41 offset:45056
  buffer_load_dwordx4 a[136:139], v18, s[20:23], s48 offen offset:2048 nt
  v_mfma_f32_32x32x16_bf16 v[80:95], a[196:199], a[208:211], v[80:95]
  ds_read_b64_tr_b16 a[226:227], v41 offset:46080
  ds_read_b64_tr_b16 a[228:229], v42 offset:45056
  buffer_load_dwordx4 a[140:143], v18, s[20:23], s48 offen offset:3072 nt
  v_mfma_f32_32x32x16_bf16 v[144:159], a[196:199], a[212:215], v[144:159]
  ds_read_b64_tr_b16 a[230:231], v42 offset:46080
  ds_read_b64_tr_b16 a[232:233], v43 offset:45056
  v_mfma_f32_32x32x16_bf16 v[208:223], a[196:199], a[216:219], v[208:223]
  ds_read_b64_tr_b16 a[234:235], v43 offset:46080
  v_mfma_f32_32x32x16_bf16 v[96:111], a[200:203], a[208:211], v[96:111]
  v_accvgpr_write_b32 a80, 0
  v_accvgpr_write_b32 a81, 0
  v_accvgpr_write_b32 a82, 0
  v_accvgpr_write_b32 a83, 0
  v_mfma_f32_32x32x16_bf16 v[160:175], a[200:203], a[212:215], v[160:175]
  v_accvgpr_write_b32 a84, 0
  v_accvgpr_write_b32 a85, 0
  v_accvgpr_write_b32 a86, 0
  v_accvgpr_write_b32 a87, 0
  v_mfma_f32_32x32x16_bf16 v[224:239], a[200:203], a[216:219], v[224:239]
  v_accvgpr_write_b32 a88, 0
  v_accvgpr_write_b32 a89, 0
  v_accvgpr_write_b32 a90, 0
  v_accvgpr_write_b32 a91, 0
  v_mfma_f32_32x32x16_bf16 v[112:127], a[204:207], a[208:211], v[112:127]
  s_add_u32 m0, s44, 8192
  s_nop 0
  buffer_load_dwordx4 v14, s[16:19], s43 offen nt lds
  v_mfma_f32_32x32x16_bf16 v[176:191], a[204:207], a[212:215], v[176:191]
  buffer_load_dwordx4 v15, s[16:19], s43 offen offset:1024 nt lds
  v_mfma_f32_32x32x16_bf16 v[240:255], a[204:207], a[216:219], v[240:255]
  buffer_load_dwordx4 v16, s[16:19], s43 offen offset:2048 nt lds
  buffer_load_dwordx4 v17, s[16:19], s43 offen offset:3072 nt lds
  s_add_u32 s43, s43, 8192
  s_cmp_ge_u32 s43, 131072
  s_cselect_b32 s18, 0, 131072
  s_waitcnt lgkmcnt(0)
  s_waitcnt vmcnt(8)
  s_barrier
  v_mfma_f32_32x32x16_bf16 v[64:79], a[220:223], a[236:239], v[64:79]
  ds_read_b128 a[208:211], v32 offset:0
  ds_read_b64_tr_b16 a[192:193], v40 offset:0
  v_mfma_f32_32x32x16_bf16 v[128:143], a[220:223], a[240:243], v[128:143]
  ds_read_b64_tr_b16 a[194:195], v40 offset:1024
  ds_read_b128 a[212:215], v32 offset:4096
  s_add_u32 m0, s40, 90112
  s_nop 0
  buffer_load_dwordx4 v44, s[8:11], s38 offen lds
  v_mfma_f32_32x32x16_bf16 v[192:207], a[220:223], a[244:247], v[192:207]
  ds_read_b128 a[216:219], v32 offset:8192
  ds_read_b64_tr_b16 a[196:197], v41 offset:0
  v_mfma_f32_32x32x16_bf16 v[80:95], a[224:227], a[236:239], v[80:95]
  ds_read_b64_tr_b16 a[198:199], v41 offset:1024
  ds_read_b64_tr_b16 a[200:201], v42 offset:0
  s_add_u32 m0, s40, 91136
  s_nop 0
  buffer_load_dwordx4 v45, s[8:11], s38 offen lds
  v_mfma_f32_32x32x16_bf16 v[144:159], a[224:227], a[240:243], v[144:159]
  ds_read_b64_tr_b16 a[202:203], v42 offset:1024
  ds_read_b64_tr_b16 a[204:205], v43 offset:0
  v_mfma_f32_32x32x16_bf16 v[208:223], a[224:227], a[244:247], v[208:223]
  ds_read_b64_tr_b16 a[206:207], v43 offset:1024
  s_add_u32 m0, s40, 92160
  s_nop 0
  buffer_load_dwordx4 v46, s[8:11], s38 offen lds
  v_mfma_f32_32x32x16_bf16 v[96:111], a[228:231], a[236:239], v[96:111]
  v_accvgpr_write_b32 a92, 0
  v_accvgpr_write_b32 a93, 0
  v_accvgpr_write_b32 a94, 0
  v_accvgpr_write_b32 a95, 0
  v_mfma_f32_32x32x16_bf16 v[160:175], a[228:231], a[240:243], v[160:175]
  s_add_u32 m0, s40, 93184
  s_nop 0
  buffer_load_dwordx4 v47, s[8:11], s38 offen lds
  v_mfma_f32_32x32x16_bf16 v[224:239], a[228:231], a[244:247], v[224:239]
  v_accvgpr_write_b32 a96, 0
  v_accvgpr_write_b32 a97, 0
  v_accvgpr_write_b32 a98, 0
  v_accvgpr_write_b32 a99, 0
  v_mfma_f32_32x32x16_bf16 v[112:127], a[232:235], a[236:239], v[112:127]
  s_add_u32 m0, s40, 94208
  s_nop 0
  buffer_load_dwordx4 v48, s[8:11], s38 offen lds
  v_mfma_f32_32x32x16_bf16 v[176:191], a[232:235], a[240:243], v[176:191]
  v_accvgpr_write_b32 a100, 0
  v_accvgpr_write_b32 a101, 0
  v_accvgpr_write_b32 a102, 0
  v_accvgpr_write_b32 a103, 0
  v_mfma_f32_32x32x16_bf16 v[240:255], a[232:235], a[244:247], v[240:255]
  s_add_u32 m0, s40, 95232
  s_nop 0
  buffer_load_dwordx4 v49, s[8:11], s38 offen lds
  s_waitcnt lgkmcnt(0)
  v_mfma_f32_32x32x16_bf16 v[64:79], a[192:195], a[208:211], v[64:79]
  ds_read_b128 a[236:239], v33 offset:0
  ds_read_b64_tr_b16 a[220:221], v40 offset:4096
  v_mfma_f32_32x32x16_bf16 v[128:143], a[192:195], a[212:215], v[128:143]
  ds_read_b64_tr_b16 a[222:223], v40 offset:5120
  ds_read_b128 a[240:243], v33 offset:4096
  s_add_u32 m0, s41, 57344
  s_nop 0
  buffer_load_dwordx4 v50, s[12:15], s39 offen lds
  v_mfma_f32_32x32x16_bf16 v[192:207], a[192:195], a[216:219], v[192:207]
  ds_read_b128 a[244:247], v33 offset:8192
  ds_read_b64_tr_b16 a[224:225], v41 offset:4096
  v_mfma_f32_32x32x16_bf16 v[80:95], a[196:199], a[208:211], v[80:95]
  ds_read_b64_tr_b16 a[226:227], v41 offset:5120
  ds_read_b64_tr_b16 a[228:229], v42 offset:4096
  s_add_u32 m0, s41, 58368
  s_nop 0
  buffer_load_dwordx4 v51, s[12:15], s39 offen lds
  v_mfma_f32_32x32x16_bf16 v[144:159], a[196:199], a[212:215], v[144:159]
  ds_read_b64_tr_b16 a[230:231], v42 offset:5120
  ds_read_b64_tr_b16 a[232:233], v43 offset:4096
  v_mfma_f32_32x32x16_bf16 v[208:223], a[196:199], a[216:219], v[208:223]
  ds_read_b64_tr_b16 a[234:235], v43 offset:5120
  v_mfma_f32_32x32x16_bf16 v[96:111], a[200:203], a[208:211], v[96:111]
  s_add_u32 m0, s41, 59392
  s_nop 0
  buffer_load_dwordx4 v52, s[12:15], s39 offen lds
  v_mfma_f32_32x32x16_bf16 v[160:175], a[200:203], a[212:215], v[160:175]
  v_accvgpr_write_b32 a104, 0
  v_accvgpr_write_b32 a105, 0
  v_accvgpr_write_b32 a106, 0
  v_accvgpr_write_b32 a107, 0
  v_mfma_f32_32x32x16_bf16 v[224:239], a[200:203], a[216:219], v[224:239]
  s_add_u32 m0, s41, 60416
  s_nop 0
  buffer_load_dwordx4 v53, s[12:15], s39 offen lds
  v_mfma_f32_32x32x16_bf16 v[112:127], a[204:207], a[208:211], v[112:127]
  v_accvgpr_write_b32 a108, 0
  v_accvgpr_write_b32 a109, 0
  v_accvgpr_write_b32 a110, 0
  v_accvgpr_write_b32 a111, 0
  v_mfma_f32_32x32x16_bf16 v[176:191], a[204:207], a[212:215], v[176:191]
  s_add_u32 m0, s41, 61440
  s_nop 0
  buffer_load_dwordx4 v54, s[12:15], s39 offen lds
  v_mfma_f32_32x32x16_bf16 v[240:255], a[204:207], a[216:219], v[240:255]
  v_accvgpr_write_b32 a112, 0
  v_accvgpr_write_b32 a113, 0
  v_accvgpr_write_b32 a114, 0
  v_accvgpr_write_b32 a115, 0
  s_waitcnt lgkmcnt(0)
  v_mfma_f32_32x32x16_bf16 v[64:79], a[220:223], a[236:239], v[64:79]
  ds_read_b128 a[208:211], v34 offset:0
  ds_read_b64_tr_b16 a[192:193], v40 offset:8192
  v_mfma_f32_32x32x16_bf16 v[128:143], a[220:223], a[240:243], v[128:143]
  ds_read_b64_tr_b16 a[194:195], v40 offset:9216
  ds_read_b128 a[212:215], v34 offset:4096
  s_add_u32 m0, s41, 62464
  s_nop 0
  buffer_load_dwordx4 v55, s[12:15], s39 offen lds
  v_mfma_f32_32x32x16_bf16 v[192:207], a[220:223], a[244:247], v[192:207]
  ds_read_b128 a[216:219], v34 offset:8192
  ds_read_b64_tr_b16 a[196:197], v41 offset:8192
  v_mfma_f32_32x32x16_bf16 v[80:95], a[224:227], a[236:239], v[80:95]
  ds_read_b64_tr_b16 a[198:199], v41 offset:9216
  ds_read_b64_tr_b16 a[200:201], v42 offset:8192
  v_mfma_f32_32x32x16_bf16 v[144:159], a[224:227], a[240:243], v[144:159]
  ds_read_b64_tr_b16 a[202:203], v42 offset:9216
  ds_read_b64_tr_b16 a[204:205], v43 offset:8192
  s_add_u32 m0, s41, 63488
  s_nop 0
  buffer_load_dwordx4 v56, s[12:15], s39 offen lds
  v_mfma_f32_32x32x16_bf16 v[208:223], a[224:227], a[244:247], v[208:223]
  ds_read_b64_tr_b16 a[206:207], v43 offset:9216
  v_mfma_f32_32x32x16_bf16 v[96:111], a[228:231], a[236:239], v[96:111]
  v_accvgpr_write_b32 a116, 0
  v_accvgpr_write_b32 a117, 0
  v_accvgpr_write_b32 a118, 0
  v_accvgpr_write_b32 a119, 0
  v_mfma_f32_32x32x16_bf16 v[160:175], a[228:231], a[240:243], v[160:175]
  s_add_u32 m0, s41, 64512
  s_nop 0
  buffer_load_dwordx4 v57, s[12:15], s39 offen lds
  v_mfma_f32_32x32x16_bf16 v[224:239], a[228:231], a[244:247], v[224:239]
  v_accvgpr_write_b32 a120, 0
  v_accvgpr_write_b32 a121, 0
  v_accvgpr_write_b32 a122, 0
  v_accvgpr_write_b32 a123, 0
  v_mfma_f32_32x32x16_bf16 v[112:127], a[232:235], a[236:239], v[112:127]
  s_add_u32 s38, s38, 128
  s_add_u32 s39, s39, 524288
  v_mfma_f32_32x32x16_bf16 v[176:191], a[232:235], a[240:243], v[176:191]
  v_accvgpr_write_b32 a124, 0
  v_accvgpr_write_b32 a125, 0
  v_accvgpr_write_b32 a126, 0
  v_accvgpr_write_b32 a127, 0
  v_mfma_f32_32x32x16_bf16 v[240:255], a[232:235], a[244:247], v[240:255]
  s_waitcnt lgkmcnt(0)
  v_mfma_f32_32x32x16_bf16 v[64:79], a[192:195], a[208:211], v[64:79]
  ds_read_b128 a[236:239], v35 offset:0
  ds_read_b64_tr_b16 a[220:221], v40 offset:12288
  s_lshl_b32 s48, s30, 12
  s_add_u32 s48, s48, 16384
  buffer_load_dwordx4 a[160:163], v18, s[20:23], s48 offen nt
  v_mfma_f32_32x32x16_bf16 v[128:143], a[192:195], a[212:215], v[128:143]
  ds_read_b64_tr_b16 a[222:223], v40 offset:13312
  ds_read_b128 a[240:243], v35 offset:4096
  buffer_load_dwordx4 a[164:167], v18, s[20:23], s48 offen offset:1024 nt
  v_mfma_f32_32x32x16_bf16 v[192:207], a[192:195], a[216:219], v[192:207]
  ds_read_b128 a[244:247], v35 offset:8192
  ds_read_b64_tr_b16 a[224:225], v41 offset:12288
  buffer_load_dwordx4 a[168:171], v18, s[20:23], s48 offen offset:2048 nt
  v_mfma_f32_32x32x16_bf16 v[80:95], a[196:199], a[208:211], v[80:95]
  ds_read_b64_tr_b16 a[226:227], v41 offset:13312
  ds_read_b64_tr_b16 a[228:229], v42 offset:12288
  buffer_load_dwordx4 a[172:175], v18, s[20:23], s48 offen offset:3072 nt
  v_mfma_f32_32x32x16_bf16 v[144:159], a[196:199], a[212:215], v[144:159]
  ds_read_b64_tr_b16 a[230:231], v42 offset:13312
  ds_read_b64_tr_b16 a[232:233], v43 offset:12288
  v_mfma_f32_32x32x16_bf16 v[208:223], a[196:199], a[216:219], v[208:223]
  ds_read_b64_tr_b16 a[234:235], v43 offset:13312
  v_mfma_f32_32x32x16_bf16 v[96:111], a[200:203], a[208:211], v[96:111]
  v_mfma_f32_32x32x16_bf16 v[160:175], a[200:203], a[212:215], v[160:175]
  v_mfma_f32_32x32x16_bf16 v[224:239], a[200:203], a[216:219], v[224:239]
  s_lshl_b32 s48, s30, 12
  s_add_u32 s48, s48, 16384
  buffer_load_dwordx4 a[144:147], v14, s[16:19], s48 offen nt
  v_mfma_f32_32x32x16_bf16 v[112:127], a[204:207], a[208:211], v[112:127]
  buffer_load_dwordx4 a[148:151], v15, s[16:19], s48 offen offset:1024 nt
  v_mfma_f32_32x32x16_bf16 v[176:191], a[204:207], a[212:215], v[176:191]
  buffer_load_dwordx4 a[152:155], v16, s[16:19], s48 offen offset:2048 nt
  v_mfma_f32_32x32x16_bf16 v[240:255], a[204:207], a[216:219], v[240:255]
  buffer_load_dwordx4 a[156:159], v17, s[16:19], s48 offen offset:3072 nt
  s_waitcnt lgkmcnt(0)
  s_waitcnt vmcnt(8)
  s_barrier
  v_mfma_f32_32x32x16_bf16 v[64:79], a[220:223], a[236:239], v[64:79]
  ds_read_b128 a[208:211], v36 offset:0
  ds_read_b64_tr_b16 a[192:193], v40 offset:32768
  v_mfma_f32_32x32x16_bf16 v[128:143], a[220:223], a[240:243], v[128:143]
  ds_read_b64_tr_b16 a[194:195], v40 offset:33792
  ds_read_b128 a[212:215], v36 offset:4096
  s_add_u32 m0, s40, 0
  s_nop 0
  buffer_load_dwordx4 v44, s[8:11], s38 offen lds
  v_mfma_f32_32x32x16_bf16 v[192:207], a[220:223], a[244:247], v[192:207]
  ds_read_b128 a[216:219], v36 offset:8192
  ds_read_b64_tr_b16 a[196:197], v41 offset:32768
  v_mfma_f32_32x32x16_bf16 v[80:95], a[224:227], a[236:239], v[80:95]
  ds_read_b64_tr_b16 a[198:199], v41 offset:33792
  ds_read_b64_tr_b16 a[200:201], v42 offset:32768
  s_add_u32 m0, s40, 1024
  s_nop 0
  buffer_load_dwordx4 v45, s[8:11], s38 offen lds
  v_mfma_f32_32x32x16_bf16 v[144:159], a[224:227], a[240:243], v[144:159]
  ds_read_b64_tr_b16 a[202:203], v42 offset:33792
  ds_read_b64_tr_b16 a[204:205], v43 offset:32768
  v_mfma_f32_32x32x16_bf16 v[208:223], a[224:227], a[244:247], v[208:223]
  ds_read_b64_tr_b16 a[206:207], v43 offset:33792
  s_add_u32 m0, s40, 2048
  s_nop 0
  buffer_load_dwordx4 v46, s[8:11], s38 offen lds
  v_mfma_f32_32x32x16_bf16 v[96:111], a[228:231], a[236:239], v[96:111]
  v_mfma_f32_32x32x16_bf16 v[160:175], a[228:231], a[240:243], v[160:175]
  s_add_u32 m0, s40, 3072
  s_nop 0
  buffer_load_dwordx4 v47, s[8:11], s38 offen lds
  v_mfma_f32_32x32x16_bf16 v[224:239], a[228:231], a[244:247], v[224:239]
  v_mfma_f32_32x32x16_bf16 v[112:127], a[232:235], a[236:239], v[112:127]
  s_add_u32 m0, s40, 4096
  s_nop 0
  buffer_load_dwordx4 v48, s[8:11], s38 offen lds
  v_mfma_f32_32x32x16_bf16 v[176:191], a[232:235], a[240:243], v[176:191]
  v_mfma_f32_32x32x16_bf16 v[240:255], a[232:235], a[244:247], v[240:255]
  s_add_u32 m0, s40, 5120
  s_nop 0
  buffer_load_dwordx4 v49, s[8:11], s38 offen lds
  s_waitcnt lgkmcnt(0)
  v_mfma_f32_32x32x16_bf16 v[64:79], a[192:195], a[208:211], v[64:79]
  ds_read_b128 a[236:239], v37 offset:0
  ds_read_b64_tr_b16 a[220:221], v40 offset:36864
  v_mfma_f32_32x32x16_bf16 v[128:143], a[192:195], a[212:215], v[128:143]
  ds_read_b64_tr_b16 a[222:223], v40 offset:37888
  ds_read_b128 a[240:243], v37 offset:4096
  s_add_u32 m0, s41, 24576
  s_nop 0
  buffer_load_dwordx4 v50, s[12:15], s39 offen lds
  v_mfma_f32_32x32x16_bf16 v[192:207], a[192:195], a[216:219], v[192:207]
  ds_read_b128 a[244:247], v37 offset:8192
  ds_read_b64_tr_b16 a[224:225], v41 offset:36864
  v_mfma_f32_32x32x16_bf16 v[80:95], a[196:199], a[208:211], v[80:95]
  ds_read_b64_tr_b16 a[226:227], v41 offset:37888
  ds_read_b64_tr_b16 a[228:229], v42 offset:36864
  s_add_u32 m0, s41, 25600
  s_nop 0
  buffer_load_dwordx4 v51, s[12:15], s39 offen lds
  v_mfma_f32_32x32x16_bf16 v[144:159], a[196:199], a[212:215], v[144:159]
  ds_read_b64_tr_b16 a[230:231], v42 offset:37888
  ds_read_b64_tr_b16 a[232:233], v43 offset:36864
  v_mfma_f32_32x32x16_bf16 v[208:223], a[196:199], a[216:219], v[208:223]
  ds_read_b64_tr_b16 a[234:235], v43 offset:37888
  v_mfma_f32_32x32x16_bf16 v[96:111], a[200:203], a[208:211], v[96:111]
  s_add_u32 m0, s41, 26624
  s_nop 0
  buffer_load_dwordx4 v52, s[12:15], s39 offen lds
  v_mfma_f32_32x32x16_bf16 v[160:175], a[200:203], a[212:215], v[160:175]
  v_mfma_f32_32x32x16_bf16 v[224:239], a[200:203], a[216:219], v[224:239]
  s_add_u32 m0, s41, 27648
  s_nop 0
  buffer_load_dwordx4 v53, s[12:15], s39 offen lds
  v_mfma_f32_32x32x16_bf16 v[112:127], a[204:207], a[208:211], v[112:127]
  v_mfma_f32_32x32x16_bf16 v[176:191], a[204:207], a[212:215], v[176:191]
  s_add_u32 m0, s41, 28672
  s_nop 0
  buffer_load_dwordx4 v54, s[12:15], s39 offen lds
  v_mfma_f32_32x32x16_bf16 v[240:255], a[204:207], a[216:219], v[240:255]
  s_waitcnt lgkmcnt(0)
  v_mfma_f32_32x32x16_bf16 v[64:79], a[220:223], a[236:239], v[64:79]
  ds_read_b128 a[208:211], v38 offset:0
  ds_read_b64_tr_b16 a[192:193], v40 offset:40960
  v_mfma_f32_32x32x16_bf16 v[128:143], a[220:223], a[240:243], v[128:143]
  ds_read_b64_tr_b16 a[194:195], v40 offset:41984
  ds_read_b128 a[212:215], v38 offset:4096
  s_add_u32 m0, s41, 29696
  s_nop 0
  buffer_load_dwordx4 v55, s[12:15], s39 offen lds
  v_mfma_f32_32x32x16_bf16 v[192:207], a[220:223], a[244:247], v[192:207]
  ds_read_b128 a[216:219], v38 offset:8192
  ds_read_b64_tr_b16 a[196:197], v41 offset:40960
  v_mfma_f32_32x32x16_bf16 v[80:95], a[224:227], a[236:239], v[80:95]
  ds_read_b64_tr_b16 a[198:199], v41 offset:41984
  ds_read_b64_tr_b16 a[200:201], v42 offset:40960
  v_mfma_f32_32x32x16_bf16 v[144:159], a[224:227], a[240:243], v[144:159]
  ds_read_b64_tr_b16 a[202:203], v42 offset:41984
  ds_read_b64_tr_b16 a[204:205], v43 offset:40960
  s_add_u32 m0, s41, 30720
  s_nop 0
  buffer_load_dwordx4 v56, s[12:15], s39 offen lds
  v_mfma_f32_32x32x16_bf16 v[208:223], a[224:227], a[244:247], v[208:223]
  ds_read_b64_tr_b16 a[206:207], v43 offset:41984
  v_mfma_f32_32x32x16_bf16 v[96:111], a[228:231], a[236:239], v[96:111]
  v_mfma_f32_32x32x16_bf16 v[160:175], a[228:231], a[240:243], v[160:175]
  s_add_u32 m0, s41, 31744
  s_nop 0
  buffer_load_dwordx4 v57, s[12:15], s39 offen lds
  v_mfma_f32_32x32x16_bf16 v[224:239], a[228:231], a[244:247], v[224:239]
  v_mfma_f32_32x32x16_bf16 v[112:127], a[232:235], a[236:239], v[112:127]
  s_add_u32 s38, s38, 128
  s_add_u32 s39, s39, 524288
  v_mfma_f32_32x32x16_bf16 v[176:191], a[232:235], a[240:243], v[176:191]
  v_mfma_f32_32x32x16_bf16 v[240:255], a[232:235], a[244:247], v[240:255]
  s_waitcnt lgkmcnt(0)
  v_mfma_f32_32x32x16_bf16 v[64:79], a[192:195], a[208:211], v[64:79]
  ds_read_b128 a[236:239], v39 offset:0
  ds_read_b64_tr_b16 a[220:221], v40 offset:45056
  v_mfma_f32_32x32x16_bf16 v[128:143], a[192:195], a[212:215], v[128:143]
  ds_read_b64_tr_b16 a[222:223], v40 offset:46080
  ds_read_b128 a[240:243], v39 offset:4096
  v_mfma_f32_32x32x16_bf16 v[192:207], a[192:195], a[216:219], v[192:207]
  ds_read_b128 a[244:247], v39 offset:8192
  ds_read_b64_tr_b16 a[224:225], v41 offset:45056
  v_mfma_f32_32x32x16_bf16 v[80:95], a[196:199], a[208:211], v[80:95]
  ds_read_b64_tr_b16 a[226:227], v41 offset:46080
  ds_read_b64_tr_b16 a[228:229], v42 offset:45056
  v_mfma_f32_32x32x16_bf16 v[144:159], a[196:199], a[212:215], v[144:159]
  ds_read_b64_tr_b16 a[230:231], v42 offset:46080
  ds_read_b64_tr_b16 a[232:233], v43 offset:45056
  v_mfma_f32_32x32x16_bf16 v[208:223], a[196:199], a[216:219], v[208:223]
  ds_read_b64_tr_b16 a[234:235], v43 offset:46080
  v_mfma_f32_32x32x16_bf16 v[96:111], a[200:203], a[208:211], v[96:111]
  v_mfma_f32_32x32x16_bf16 v[160:175], a[200:203], a[212:215], v[160:175]
  v_mfma_f32_32x32x16_bf16 v[224:239], a[200:203], a[216:219], v[224:239]
  s_lshl_b32 s48, s30, 12
  s_add_u32 s48, s48, 24576
  buffer_load_dwordx4 a[176:179], v14, s[16:19], s48 offen nt
  v_mfma_f32_32x32x16_bf16 v[112:127], a[204:207], a[208:211], v[112:127]
  buffer_load_dwordx4 a[180:183], v15, s[16:19], s48 offen offset:1024 nt
  v_mfma_f32_32x32x16_bf16 v[176:191], a[204:207], a[212:215], v[176:191]
  buffer_load_dwordx4 a[184:187], v16, s[16:19], s48 offen offset:2048 nt
  v_mfma_f32_32x32x16_bf16 v[240:255], a[204:207], a[216:219], v[240:255]
  buffer_load_dwordx4 a[188:191], v17, s[16:19], s48 offen offset:3072 nt
  s_waitcnt lgkmcnt(0)
  s_waitcnt vmcnt(4)
  s_barrier
  v_mfma_f32_32x32x16_bf16 v[64:79], a[220:223], a[236:239], v[64:79]
  ds_read_b128 a[208:211], v32 offset:0
  ds_read_b64_tr_b16 a[192:193], v40 offset:0
  v_mfma_f32_32x32x16_bf16 v[128:143], a[220:223], a[240:243], v[128:143]
  ds_read_b64_tr_b16 a[194:195], v40 offset:1024
  ds_read_b128 a[212:215], v32 offset:4096
  s_add_u32 m0, s40, 90112
  s_nop 0
  buffer_load_dwordx4 v44, s[8:11], s38 offen lds
  v_mfma_f32_32x32x16_bf16 v[192:207], a[220:223], a[244:247], v[192:207]
  ds_read_b128 a[216:219], v32 offset:8192
  ds_read_b64_tr_b16 a[196:197], v41 offset:0
  v_mfma_f32_32x32x16_bf16 v[80:95], a[224:227], a[236:239], v[80:95]
  ds_read_b64_tr_b16 a[198:199], v41 offset:1024
  ds_read_b64_tr_b16 a[200:201], v42 offset:0
  s_add_u32 m0, s40, 91136
  s_nop 0
  buffer_load_dwordx4 v45, s[8:11], s38 offen lds
  v_mfma_f32_32x32x16_bf16 v[144:159], a[224:227], a[240:243], v[144:159]
  ds_read_b64_tr_b16 a[202:203], v42 offset:1024
  ds_read_b64_tr_b16 a[204:205], v43 offset:0
  v_mfma_f32_32x32x16_bf16 v[208:223], a[224:227], a[244:247], v[208:223]
  ds_read_b64_tr_b16 a[206:207], v43 offset:1024
  s_add_u32 m0, s40, 92160
  s_nop 0
  buffer_load_dwordx4 v46, s[8:11], s38 offen lds
  v_mfma_f32_32x32x16_bf16 v[96:111], a[228:231], a[236:239], v[96:111]
  v_mfma_f32_32x32x16_bf16 v[160:175], a[228:231], a[240:243], v[160:175]
  s_add_u32 m0, s40, 93184
  s_nop 0
  buffer_load_dwordx4 v47, s[8:11], s38 offen lds
  v_mfma_f32_32x32x16_bf16 v[224:239], a[228:231], a[244:247], v[224:239]
  v_mfma_f32_32x32x16_bf16 v[112:127], a[232:235], a[236:239], v[112:127]
  s_add_u32 m0, s40, 94208
  s_nop 0
  buffer_load_dwordx4 v48, s[8:11], s38 offen lds
  v_mfma_f32_32x32x16_bf16 v[176:191], a[232:235], a[240:243], v[176:191]
  v_mfma_f32_32x32x16_bf16 v[240:255], a[232:235], a[244:247], v[240:255]
  s_add_u32 m0, s40, 95232
  s_nop 0
  buffer_load_dwordx4 v49, s[8:11], s38 offen lds
  s_waitcnt lgkmcnt(0)
  v_mfma_f32_32x32x16_bf16 v[64:79], a[192:195], a[208:211], v[64:79]
  ds_read_b128 a[236:239], v33 offset:0
  ds_read_b64_tr_b16 a[220:221], v40 offset:4096
  v_mfma_f32_32x32x16_bf16 v[128:143], a[192:195], a[212:215], v[128:143]
  ds_read_b64_tr_b16 a[222:223], v40 offset:5120
  ds_read_b128 a[240:243], v33 offset:4096
  s_add_u32 m0, s41, 57344
  s_nop 0
  buffer_load_dwordx4 v50, s[12:15], s39 offen lds
  v_mfma_f32_32x32x16_bf16 v[192:207], a[192:195], a[216:219], v[192:207]
  ds_read_b128 a[244:247], v33 offset:8192
  ds_read_b64_tr_b16 a[224:225], v41 offset:4096
  v_mfma_f32_32x32x16_bf16 v[80:95], a[196:199], a[208:211], v[80:95]
  ds_read_b64_tr_b16 a[226:227], v41 offset:5120
  ds_read_b64_tr_b16 a[228:229], v42 offset:4096
  s_add_u32 m0, s41, 58368
  s_nop 0
  buffer_load_dwordx4 v51, s[12:15], s39 offen lds
  v_mfma_f32_32x32x16_bf16 v[144:159], a[196:199], a[212:215], v[144:159]
  ds_read_b64_tr_b16 a[230:231], v42 offset:5120
  ds_read_b64_tr_b16 a[232:233], v43 offset:4096
  v_mfma_f32_32x32x16_bf16 v[208:223], a[196:199], a[216:219], v[208:223]
  ds_read_b64_tr_b16 a[234:235], v43 offset:5120
  v_mfma_f32_32x32x16_bf16 v[96:111], a[200:203], a[208:211], v[96:111]
  s_add_u32 m0, s41, 59392
  s_nop 0
  buffer_load_dwordx4 v52, s[12:15], s39 offen lds
  v_mfma_f32_32x32x16_bf16 v[160:175], a[200:203], a[212:215], v[160:175]
  v_mfma_f32_32x32x16_bf16 v[224:239], a[200:203], a[216:219], v[224:239]
  s_add_u32 m0, s41, 60416
  s_nop 0
  buffer_load_dwordx4 v53, s[12:15], s39 offen lds
  v_mfma_f32_32x32x16_bf16 v[112:127], a[204:207], a[208:211], v[112:127]
  v_mfma_f32_32x32x16_bf16 v[176:191], a[204:207], a[212:215], v[176:191]
  s_add_u32 m0, s41, 61440
  s_nop 0
  buffer_load_dwordx4 v54, s[12:15], s39 offen lds
  v_mfma_f32_32x32x16_bf16 v[240:255], a[204:207], a[216:219], v[240:255]
  s_waitcnt lgkmcnt(0)
  v_mfma_f32_32x32x16_bf16 v[64:79], a[220:223], a[236:239], v[64:79]
  ds_read_b128 a[208:211], v34 offset:0
  ds_read_b64_tr_b16 a[192:193], v40 offset:8192
  v_mfma_f32_32x32x16_bf16 v[128:143], a[220:223], a[240:243], v[128:143]
  ds_read_b64_tr_b16 a[194:195], v40 offset:9216
  ds_read_b128 a[212:215], v34 offset:4096
  s_add_u32 m0, s41, 62464
  s_nop 0
  buffer_load_dwordx4 v55, s[12:15], s39 offen lds
  v_mfma_f32_32x32x16_bf16 v[192:207], a[220:223], a[244:247], v[192:207]
  ds_read_b128 a[216:219], v34 offset:8192
  ds_read_b64_tr_b16 a[196:197], v41 offset:8192
  v_mfma_f32_32x32x16_bf16 v[80:95], a[224:227], a[236:239], v[80:95]
  ds_read_b64_tr_b16 a[198:199], v41 offset:9216
  ds_read_b64_tr_b16 a[200:201], v42 offset:8192
  v_mfma_f32_32x32x16_bf16 v[144:159], a[224:227], a[240:243], v[144:159]
  ds_read_b64_tr_b16 a[202:203], v42 offset:9216
  ds_read_b64_tr_b16 a[204:205], v43 offset:8192
  s_add_u32 m0, s41, 63488
  s_nop 0
  buffer_load_dwordx4 v56, s[12:15], s39 offen lds
  v_mfma_f32_32x32x16_bf16 v[208:223], a[224:227], a[244:247], v[208:223]
  ds_read_b64_tr_b16 a[206:207], v43 offset:9216
  v_mfma_f32_32x32x16_bf16 v[96:111], a[228:231], a[236:239], v[96:111]
  v_mfma_f32_32x32x16_bf16 v[160:175], a[228:231], a[240:243], v[160:175]
  s_add_u32 m0, s41, 64512
  s_nop 0
  buffer_load_dwordx4 v57, s[12:15], s39 offen lds
  v_mfma_f32_32x32x16_bf16 v[224:239], a[228:231], a[244:247], v[224:239]
  v_mfma_f32_32x32x16_bf16 v[112:127], a[232:235], a[236:239], v[112:127]
  s_add_u32 s38, s38, 128
  s_add_u32 s39, s39, 524288
  v_mfma_f32_32x32x16_bf16 v[176:191], a[232:235], a[240:243], v[176:191]
  v_mfma_f32_32x32x16_bf16 v[240:255], a[232:235], a[244:247], v[240:255]
  s_waitcnt lgkmcnt(0)
  v_mfma_f32_32x32x16_bf16 v[64:79], a[192:195], a[208:211], v[64:79]
  ds_read_b128 a[236:239], v35 offset:0
  ds_read_b64_tr_b16 a[220:221], v40 offset:12288
  v_mfma_f32_32x32x16_bf16 v[128:143], a[192:195], a[212:215], v[128:143]
  ds_read_b64_tr_b16 a[222:223], v40 offset:13312
  ds_read_b128 a[240:243], v35 offset:4096
  v_mfma_f32_32x32x16_bf16 v[192:207], a[192:195], a[216:219], v[192:207]
  ds_read_b128 a[244:247], v35 offset:8192
  ds_read_b64_tr_b16 a[224:225], v41 offset:12288
  v_mfma_f32_32x32x16_bf16 v[80:95], a[196:199], a[208:211], v[80:95]
  ds_read_b64_tr_b16 a[226:227], v41 offset:13312
  ds_read_b64_tr_b16 a[228:229], v42 offset:12288
  v_mfma_f32_32x32x16_bf16 v[144:159], a[196:199], a[212:215], v[144:159]
  ds_read_b64_tr_b16 a[230:231], v42 offset:13312
  ds_read_b64_tr_b16 a[232:233], v43 offset:12288
  v_mfma_f32_32x32x16_bf16 v[208:223], a[196:199], a[216:219], v[208:223]
  ds_read_b64_tr_b16 a[234:235], v43 offset:13312
  v_mfma_f32_32x32x16_bf16 v[96:111], a[200:203], a[208:211], v[96:111]
  v_mfma_f32_32x32x16_bf16 v[160:175], a[200:203], a[212:215], v[160:175]
  v_mfma_f32_32x32x16_bf16 v[224:239], a[200:203], a[216:219], v[224:239]
  v_mfma_f32_32x32x16_bf16 v[112:127], a[204:207], a[208:211], v[112:127]
  v_mfma_f32_32x32x16_bf16 v[176:191], a[204:207], a[212:215], v[176:191]
  v_mfma_f32_32x32x16_bf16 v[240:255], a[204:207], a[216:219], v[240:255]
  s_waitcnt lgkmcnt(0)
  s_waitcnt vmcnt(0)
  s_barrier
  v_mfma_f32_32x32x16_bf16 v[64:79], a[220:223], a[236:239], v[64:79]
  ds_read_b128 a[208:211], v36 offset:0
  ds_read_b64_tr_b16 a[192:193], v40 offset:32768
  v_add_u32 v31, s50, v24
  s_waitcnt vmcnt(32)
  s_add_u32 s42, s42, 16384
  s_add_u32 s43, s43, 16384
  v_mfma_f32_32x32x16_bf16 v[128:143], a[220:223], a[240:243], v[128:143]
  ds_read_b64_tr_b16 a[194:195], v40 offset:33792
  ds_read_b128 a[212:215], v36 offset:4096
  ds_write_b128 v31, a[128:131] offset:0
  v_mfma_f32_32x32x16_bf16 v[192:207], a[220:223], a[244:247], v[192:207]
  ds_read_b128 a[216:219], v36 offset:8192
  ds_read_b64_tr_b16 a[196:197], v41 offset:32768
  v_mfma_f32_32x32x16_bf16 v[80:95], a[224:227], a[236:239], v[80:95]
  ds_read_b64_tr_b16 a[198:199], v41 offset:33792
  ds_read_b64_tr_b16 a[200:201], v42 offset:32768
  v_mfma_f32_32x32x16_bf16 v[144:159], a[224:227], a[240:243], v[144:159]
  ds_read_b64_tr_b16 a[202:203], v42 offset:33792
  ds_read_b64_tr_b16 a[204:205], v43 offset:32768
  ds_write_b128 v31, a[132:135] offset:1024
  v_mfma_f32_32x32x16_bf16 v[208:223], a[224:227], a[244:247], v[208:223]
  ds_read_b64_tr_b16 a[206:207], v43 offset:33792
  v_mfma_f32_32x32x16_bf16 v[96:111], a[228:231], a[236:239], v[96:111]
  v_mfma_f32_32x32x16_bf16 v[160:175], a[228:231], a[240:243], v[160:175]
  ds_write_b128 v31, a[136:139] offset:2048
  v_mfma_f32_32x32x16_bf16 v[224:239], a[228:231], a[244:247], v[224:239]
  v_mfma_f32_32x32x16_bf16 v[112:127], a[232:235], a[236:239], v[112:127]
  v_mfma_f32_32x32x16_bf16 v[176:191], a[232:235], a[240:243], v[176:191]
  ds_write_b128 v31, a[140:143] offset:3072
  v_mfma_f32_32x32x16_bf16 v[240:255], a[232:235], a[244:247], v[240:255]
  s_waitcnt lgkmcnt(0)
  v_mfma_f32_32x32x16_bf16 v[64:79], a[192:195], a[208:211], v[64:79]
  ds_read_b128 a[236:239], v37 offset:0
  ds_read_b64_tr_b16 a[220:221], v40 offset:36864
  v_mfma_f32_32x32x16_bf16 v[128:143], a[192:195], a[212:215], v[128:143]
  ds_read_b64_tr_b16 a[222:223], v40 offset:37888
  ds_read_b128 a[240:243], v37 offset:4096
  v_mfma_f32_32x32x16_bf16 v[192:207], a[192:195], a[216:219], v[192:207]
  ds_read_b128 a[244:247], v37 offset:8192
  ds_read_b64_tr_b16 a[224:225], v41 offset:36864
  v_mfma_f32_32x32x16_bf16 v[80:95], a[196:199], a[208:211], v[80:95]
  ds_read_b64_tr_b16 a[226:227], v41 offset:37888
  ds_read_b64_tr_b16 a[228:229], v42 offset:36864
  v_mfma_f32_32x32x16_bf16 v[144:159], a[196:199], a[212:215], v[144:159]
  ds_read_b64_tr_b16 a[230:231], v42 offset:37888
  ds_read_b64_tr_b16 a[232:233], v43 offset:36864
  v_mfma_f32_32x32x16_bf16 v[208:223], a[196:199], a[216:219], v[208:223]
  ds_read_b64_tr_b16 a[234:235], v43 offset:37888
  ds_write_b128 v31, a[144:147] offset:8192
  v_mfma_f32_32x32x16_bf16 v[96:111], a[200:203], a[208:211], v[96:111]
  v_mfma_f32_32x32x16_bf16 v[160:175], a[200:203], a[212:215], v[160:175]
  ds_write_b128 v31, a[148:151] offset:9216
  v_mfma_f32_32x32x16_bf16 v[224:239], a[200:203], a[216:219], v[224:239]
  v_mfma_f32_32x32x16_bf16 v[112:127], a[204:207], a[208:211], v[112:127]
  ds_write_b128 v31, a[152:155] offset:10240
  v_mfma_f32_32x32x16_bf16 v[176:191], a[204:207], a[212:215], v[176:191]
  v_mfma_f32_32x32x16_bf16 v[240:255], a[204:207], a[216:219], v[240:255]
  ds_write_b128 v31, a[156:159] offset:11264
  s_waitcnt lgkmcnt(0)
  v_mfma_f32_32x32x16_bf16 v[64:79], a[220:223], a[236:239], v[64:79]
  ds_read_b128 a[208:211], v38 offset:0
  ds_read_b64_tr_b16 a[192:193], v40 offset:40960
  v_mfma_f32_32x32x16_bf16 v[128:143], a[220:223], a[240:243], v[128:143]
  ds_read_b64_tr_b16 a[194:195], v40 offset:41984
  ds_read_b128 a[212:215], v38 offset:4096
  v_mfma_f32_32x32x16_bf16 v[192:207], a[220:223], a[244:247], v[192:207]
  ds_read_b128 a[216:219], v38 offset:8192
  ds_read_b64_tr_b16 a[196:197], v41 offset:40960
  v_mfma_f32_32x32x16_bf16 v[80:95], a[224:227], a[236:239], v[80:95]
  ds_read_b64_tr_b16 a[198:199], v41 offset:41984
  ds_read_b64_tr_b16 a[200:201], v42 offset:40960
  v_mfma_f32_32x32x16_bf16 v[144:159], a[224:227], a[240:243], v[144:159]
  ds_read_b64_tr_b16 a[202:203], v42 offset:41984
  ds_read_b64_tr_b16 a[204:205], v43 offset:40960
  v_accvgpr_write_b32 a128, 0
  v_accvgpr_write_b32 a129, 0
  v_accvgpr_write_b32 a130, 0
  v_accvgpr_write_b32 a131, 0
  v_mfma_f32_32x32x16_bf16 v[208:223], a[224:227], a[244:247], v[208:223]
  ds_read_b64_tr_b16 a[206:207], v43 offset:41984
  s_waitcnt vmcnt(14)
  ds_write_b128 v31, a[160:163] offset:32768
  v_mfma_f32_32x32x16_bf16 v[96:111], a[228:231], a[236:239], v[96:111]
  v_accvgpr_write_b32 a132, 0
  v_accvgpr_write_b32 a133, 0
  v_accvgpr_write_b32 a134, 0
  v_accvgpr_write_b32 a135, 0
  v_mfma_f32_32x32x16_bf16 v[160:175], a[228:231], a[240:243], v[160:175]
  ds_write_b128 v31, a[164:167] offset:33792
  v_mfma_f32_32x32x16_bf16 v[224:239], a[228:231], a[244:247], v[224:239]
  v_accvgpr_write_b32 a136, 0
  v_accvgpr_write_b32 a137, 0
  v_accvgpr_write_b32 a138, 0
  v_accvgpr_write_b32 a139, 0
  v_mfma_f32_32x32x16_bf16 v[112:127], a[232:235], a[236:239], v[112:127]
  ds_write_b128 v31, a[168:171] offset:34816
  v_mfma_f32_32x32x16_bf16 v[176:191], a[232:235], a[240:243], v[176:191]
  v_accvgpr_write_b32 a140, 0
  v_accvgpr_write_b32 a141, 0
  v_accvgpr_write_b32 a142, 0
  v_accvgpr_write_b32 a143, 0
  v_mfma_f32_32x32x16_bf16 v[240:255], a[232:235], a[244:247], v[240:255]
  ds_write_b128 v31, a[172:175] offset:35840
  s_waitcnt lgkmcnt(0)
  v_mfma_f32_32x32x16_bf16 v[64:79], a[192:195], a[208:211], v[64:79]
  ds_read_b128 a[236:239], v39 offset:0
  ds_read_b64_tr_b16 a[220:221], v40 offset:45056
  v_mfma_f32_32x32x16_bf16 v[128:143], a[192:195], a[212:215], v[128:143]
  ds_read_b64_tr_b16 a[222:223], v40 offset:46080
  ds_read_b128 a[240:243], v39 offset:4096
  v_mfma_f32_32x32x16_bf16 v[192:207], a[192:195], a[216:219], v[192:207]
  ds_read_b128 a[244:247], v39 offset:8192
  ds_read_b64_tr_b16 a[224:225], v41 offset:45056
  v_mfma_f32_32x32x16_bf16 v[80:95], a[196:199], a[208:211], v[80:95]
  ds_read_b64_tr_b16 a[226:227], v41 offset:46080
  ds_read_b64_tr_b16 a[228:229], v42 offset:45056
  v_mfma_f32_32x32x16_bf16 v[144:159], a[196:199], a[212:215], v[144:159]
  ds_read_b64_tr_b16 a[230:231], v42 offset:46080
  ds_read_b64_tr_b16 a[232:233], v43 offset:45056
  v_accvgpr_write_b32 a160, 0
  v_accvgpr_write_b32 a161, 0
  v_accvgpr_write_b32 a162, 0
  v_accvgpr_write_b32 a163, 0
  v_mfma_f32_32x32x16_bf16 v[208:223], a[196:199], a[216:219], v[208:223]
  ds_read_b64_tr_b16 a[234:235], v43 offset:46080
  v_accvgpr_write_b32 a144, 0
  v_accvgpr_write_b32 a145, 0
  v_accvgpr_write_b32 a146, 0
  v_accvgpr_write_b32 a147, 0
  v_mfma_f32_32x32x16_bf16 v[96:111], a[200:203], a[208:211], v[96:111]
  v_accvgpr_write_b32 a164, 0
  v_accvgpr_write_b32 a165, 0
  v_accvgpr_write_b32 a166, 0
  v_accvgpr_write_b32 a167, 0
  v_mfma_f32_32x32x16_bf16 v[160:175], a[200:203], a[212:215], v[160:175]
  v_accvgpr_write_b32 a148, 0
  v_accvgpr_write_b32 a149, 0
  v_accvgpr_write_b32 a150, 0
  v_accvgpr_write_b32 a151, 0
  v_mfma_f32_32x32x16_bf16 v[224:239], a[200:203], a[216:219], v[224:239]
  v_accvgpr_write_b32 a168, 0
  v_accvgpr_write_b32 a169, 0
  v_accvgpr_write_b32 a170, 0
  v_accvgpr_write_b32 a171, 0
  v_mfma_f32_32x32x16_bf16 v[112:127], a[204:207], a[208:211], v[112:127]
  v_accvgpr_write_b32 a152, 0
  v_accvgpr_write_b32 a153, 0
  v_accvgpr_write_b32 a154, 0
  v_accvgpr_write_b32 a155, 0
  v_mfma_f32_32x32x16_bf16 v[176:191], a[204:207], a[212:215], v[176:191]
  v_accvgpr_write_b32 a172, 0
  v_accvgpr_write_b32 a173, 0
  v_accvgpr_write_b32 a174, 0
  v_accvgpr_write_b32 a175, 0
  v_mfma_f32_32x32x16_bf16 v[240:255], a[204:207], a[216:219], v[240:255]
  v_accvgpr_write_b32 a156, 0
  v_accvgpr_write_b32 a157, 0
  v_accvgpr_write_b32 a158, 0
  v_accvgpr_write_b32 a159, 0
  s_waitcnt lgkmcnt(0)
  s_barrier
  v_mfma_f32_32x32x16_bf16 v[64:79], a[220:223], a[236:239], v[64:79]
  ds_write_b128 v31, a[176:179] offset:40960
  v_mfma_f32_32x32x16_bf16 v[128:143], a[220:223], a[240:243], v[128:143]
  ds_write_b128 v31, a[180:183] offset:41984
  v_mfma_f32_32x32x16_bf16 v[192:207], a[220:223], a[244:247], v[192:207]
  ds_write_b128 v31, a[184:187] offset:43008
  v_mfma_f32_32x32x16_bf16 v[80:95], a[224:227], a[236:239], v[80:95]
  ds_write_b128 v31, a[188:191] offset:44032
  s_add_u32 s44, s50, 65536
  v_mfma_f32_32x32x16_bf16 v[144:159], a[224:227], a[240:243], v[144:159]
  s_mov_b32 m0, s44
  s_nop 0
  buffer_load_dwordx4 v18, s[20:23], s42 offen nt lds
  v_mfma_f32_32x32x16_bf16 v[208:223], a[224:227], a[244:247], v[208:223]
  buffer_load_dwordx4 v18, s[20:23], s42 offen offset:1024 nt lds
  v_mfma_f32_32x32x16_bf16 v[96:111], a[228:231], a[236:239], v[96:111]
  buffer_load_dwordx4 v18, s[20:23], s42 offen offset:2048 nt lds
  v_mfma_f32_32x32x16_bf16 v[160:175], a[228:231], a[240:243], v[160:175]
  buffer_load_dwordx4 v18, s[20:23], s42 offen offset:3072 nt lds
  s_add_u32 s42, s42, 8192
  s_cmp_ge_u32 s42, 131072
  s_cselect_b32 s22, 0, 131072
  v_mfma_f32_32x32x16_bf16 v[224:239], a[228:231], a[244:247], v[224:239]
  s_add_u32 m0, s44, 8192
  s_nop 0
  buffer_load_dwordx4 v14, s[16:19], s43 offen nt lds
  v_mfma_f32_32x32x16_bf16 v[112:127], a[232:235], a[236:239], v[112:127]
  buffer_load_dwordx4 v15, s[16:19], s43 offen offset:1024 nt lds
  v_mfma_f32_32x32x16_bf16 v[176:191], a[232:235], a[240:243], v[176:191]
  buffer_load_dwordx4 v16, s[16:19], s43 offen offset:2048 nt lds
  v_mfma_f32_32x32x16_bf16 v[240:255], a[232:235], a[244:247], v[240:255]
  buffer_load_dwordx4 v17, s[16:19], s43 offen offset:3072 nt lds
  s_add_u32 s43, s43, 8192
  s_cmp_ge_u32 s43, 131072
  s_cselect_b32 s18, 0, 131072
  ds_read_b128 a[224:227], v2
  ds_read_b128 a[228:231], v3
  ds_read_b128 a[232:235], v4
  ds_read_b128 a[236:239], v5
  ds_read_b128 a[240:243], v6
  ds_read_b128 a[244:247], v7
  ds_read_b128 a[248:251], v8
  ds_read_b128 a[252:255], v9
  s_lshl_b32 s31, s29, 13
  s_add_u32 s31, s31, 24576
  s_nop 7
  v_add_u32 v2, s31, v2
  v_add_u32 v3, s31, v3
  v_add_u32 v4, s31, v4
  v_add_u32 v5, s31, v5
  v_add_u32 v6, s31, v6
  v_add_u32 v7, s31, v7
  v_add_u32 v8, s31, v8
  v_add_u32 v9, s31, v9
  s_mov_b32 s49, 0x3e0293ee
  s_mov_b32 s95, 0x3e0293ee
  s_mov_b32 s48, s49
  v_accvgpr_write_b32 a176, 0
  v_accvgpr_write_b32 a177, 0
  v_accvgpr_write_b32 a178, 0
  v_accvgpr_write_b32 a179, 0
  v_accvgpr_write_b32 a180, 0
  v_accvgpr_write_b32 a181, 0
  v_accvgpr_write_b32 a182, 0
  v_accvgpr_write_b32 a183, 0
  v_accvgpr_write_b32 a184, 0
  v_accvgpr_write_b32 a185, 0
  v_accvgpr_write_b32 a186, 0
  v_accvgpr_write_b32 a187, 0
  v_accvgpr_write_b32 a188, 0
  v_accvgpr_write_b32 a189, 0
  v_accvgpr_write_b32 a190, 0
  v_accvgpr_write_b32 a191, 0
  s_mov_b32 s94, s95
  v_pk_mul_f32 v[64:65], v[64:65], s[94:95]
  v_pk_mul_f32 v[66:67], v[66:67], s[94:95]
  v_pk_mul_f32 v[68:69], v[68:69], s[94:95]
  v_pk_mul_f32 v[70:71], v[70:71], s[94:95]
  v_pk_mul_f32 v[72:73], v[72:73], s[94:95]
  v_pk_mul_f32 v[74:75], v[74:75], s[94:95]
  v_pk_mul_f32 v[76:77], v[76:77], s[94:95]
  v_pk_mul_f32 v[78:79], v[78:79], s[94:95]
  v_cvt_pk_bf16_f32 v64, v64, v65
  v_cvt_pk_bf16_f32 v65, v66, v67
  v_cvt_pk_bf16_f32 v66, v68, v69
  v_cvt_pk_bf16_f32 v67, v70, v71
  v_cvt_pk_bf16_f32 v68, v72, v73
  v_cvt_pk_bf16_f32 v69, v74, v75
  v_cvt_pk_bf16_f32 v70, v76, v77
  v_cvt_pk_bf16_f32 v71, v78, v79
  v_pk_mul_f32 v[80:81], v[80:81], s[94:95]
  v_pk_mul_f32 v[82:83], v[82:83], s[94:95]
  v_pk_mul_f32 v[84:85], v[84:85], s[94:95]
  v_pk_mul_f32 v[86:87], v[86:87], s[94:95]
  v_pk_mul_f32 v[88:89], v[88:89], s[94:95]
  v_pk_mul_f32 v[90:91], v[90:91], s[94:95]
  v_pk_mul_f32 v[92:93], v[92:93], s[94:95]
  v_pk_mul_f32 v[94:95], v[94:95], s[94:95]
  v_cvt_pk_bf16_f32 v72, v80, v81
  v_cvt_pk_bf16_f32 v73, v82, v83
  v_cvt_pk_bf16_f32 v74, v84, v85
  v_cvt_pk_bf16_f32 v75, v86, v87
  v_cvt_pk_bf16_f32 v76, v88, v89
  v_cvt_pk_bf16_f32 v77, v90, v91
  v_cvt_pk_bf16_f32 v78, v92, v93
  v_cvt_pk_bf16_f32 v79, v94, v95
  v_pk_mul_f32 v[96:97], v[96:97], s[94:95]
  v_pk_mul_f32 v[98:99], v[98:99], s[94:95]
  v_pk_mul_f32 v[100:101], v[100:101], s[94:95]
  v_pk_mul_f32 v[102:103], v[102:103], s[94:95]
  v_pk_mul_f32 v[104:105], v[104:105], s[94:95]
  v_pk_mul_f32 v[106:107], v[106:107], s[94:95]
  v_pk_mul_f32 v[108:109], v[108:109], s[94:95]
  v_pk_mul_f32 v[110:111], v[110:111], s[94:95]
  v_cvt_pk_bf16_f32 v80, v96, v97
  v_cvt_pk_bf16_f32 v81, v98, v99
  v_cvt_pk_bf16_f32 v82, v100, v101
  v_cvt_pk_bf16_f32 v83, v102, v103
  v_cvt_pk_bf16_f32 v84, v104, v105
  v_cvt_pk_bf16_f32 v85, v106, v107
  v_cvt_pk_bf16_f32 v86, v108, v109
  v_cvt_pk_bf16_f32 v87, v110, v111
  v_pk_mul_f32 v[112:113], v[112:113], s[94:95]
  v_pk_mul_f32 v[114:115], v[114:115], s[94:95]
  v_pk_mul_f32 v[116:117], v[116:117], s[94:95]
  v_pk_mul_f32 v[118:119], v[118:119], s[94:95]
  v_pk_mul_f32 v[120:121], v[120:121], s[94:95]
  v_pk_mul_f32 v[122:123], v[122:123], s[94:95]
  v_pk_mul_f32 v[124:125], v[124:125], s[94:95]
  v_pk_mul_f32 v[126:127], v[126:127], s[94:95]
  v_cvt_pk_bf16_f32 v88, v112, v113
  v_cvt_pk_bf16_f32 v89, v114, v115
  v_cvt_pk_bf16_f32 v90, v116, v117
  v_cvt_pk_bf16_f32 v91, v118, v119
  v_cvt_pk_bf16_f32 v92, v120, v121
  v_cvt_pk_bf16_f32 v93, v122, v123
  v_cvt_pk_bf16_f32 v94, v124, v125
  v_cvt_pk_bf16_f32 v95, v126, v127
  v_pk_mul_f32 v[128:129], v[128:129], s[94:95]
  v_pk_mul_f32 v[130:131], v[130:131], s[94:95]
  v_pk_mul_f32 v[132:133], v[132:133], s[94:95]
  v_pk_mul_f32 v[134:135], v[134:135], s[94:95]
  v_pk_mul_f32 v[136:137], v[136:137], s[94:95]
  v_pk_mul_f32 v[138:139], v[138:139], s[94:95]
  v_pk_mul_f32 v[140:141], v[140:141], s[94:95]
  v_pk_mul_f32 v[142:143], v[142:143], s[94:95]
  v_cvt_pk_bf16_f32 v96, v128, v129
  v_cvt_pk_bf16_f32 v97, v130, v131
  v_cvt_pk_bf16_f32 v98, v132, v133
  v_cvt_pk_bf16_f32 v99, v134, v135
  v_cvt_pk_bf16_f32 v100, v136, v137
  v_cvt_pk_bf16_f32 v101, v138, v139
  v_cvt_pk_bf16_f32 v102, v140, v141
  v_cvt_pk_bf16_f32 v103, v142, v143
  v_pk_mul_f32 v[144:145], v[144:145], s[94:95]
  v_pk_mul_f32 v[146:147], v[146:147], s[94:95]
  v_pk_mul_f32 v[148:149], v[148:149], s[94:95]
  v_pk_mul_f32 v[150:151], v[150:151], s[94:95]
  v_pk_mul_f32 v[152:153], v[152:153], s[94:95]
  v_pk_mul_f32 v[154:155], v[154:155], s[94:95]
  v_pk_mul_f32 v[156:157], v[156:157], s[94:95]
  v_pk_mul_f32 v[158:159], v[158:159], s[94:95]
  v_cvt_pk_bf16_f32 v104, v144, v145
  v_cvt_pk_bf16_f32 v105, v146, v147
  v_cvt_pk_bf16_f32 v106, v148, v149
  v_cvt_pk_bf16_f32 v107, v150, v151
  v_cvt_pk_bf16_f32 v108, v152, v153
  v_cvt_pk_bf16_f32 v109, v154, v155
  v_cvt_pk_bf16_f32 v110, v156, v157
  v_cvt_pk_bf16_f32 v111, v158, v159
  v_pk_mul_f32 v[160:161], v[160:161], s[94:95]
  v_pk_mul_f32 v[162:163], v[162:163], s[94:95]
  v_pk_mul_f32 v[164:165], v[164:165], s[94:95]
  v_pk_mul_f32 v[166:167], v[166:167], s[94:95]
  v_pk_mul_f32 v[168:169], v[168:169], s[94:95]
  v_pk_mul_f32 v[170:171], v[170:171], s[94:95]
  v_pk_mul_f32 v[172:173], v[172:173], s[94:95]
  v_pk_mul_f32 v[174:175], v[174:175], s[94:95]
  v_cvt_pk_bf16_f32 v112, v160, v161
  v_cvt_pk_bf16_f32 v113, v162, v163
  v_cvt_pk_bf16_f32 v114, v164, v165
  v_cvt_pk_bf16_f32 v115, v166, v167
  v_cvt_pk_bf16_f32 v116, v168, v169
  v_cvt_pk_bf16_f32 v117, v170, v171
  v_cvt_pk_bf16_f32 v118, v172, v173
  v_cvt_pk_bf16_f32 v119, v174, v175
  v_pk_mul_f32 v[176:177], v[176:177], s[94:95]
  v_pk_mul_f32 v[178:179], v[178:179], s[94:95]
  v_pk_mul_f32 v[180:181], v[180:181], s[94:95]
  v_pk_mul_f32 v[182:183], v[182:183], s[94:95]
  v_pk_mul_f32 v[184:185], v[184:185], s[94:95]
  v_pk_mul_f32 v[186:187], v[186:187], s[94:95]
  v_pk_mul_f32 v[188:189], v[188:189], s[94:95]
  v_pk_mul_f32 v[190:191], v[190:191], s[94:95]
  v_cvt_pk_bf16_f32 v120, v176, v177
  v_cvt_pk_bf16_f32 v121, v178, v179
  v_cvt_pk_bf16_f32 v122, v180, v181
  v_cvt_pk_bf16_f32 v123, v182, v183
  v_cvt_pk_bf16_f32 v124, v184, v185
  v_cvt_pk_bf16_f32 v125, v186, v187
  v_cvt_pk_bf16_f32 v126, v188, v189
  v_cvt_pk_bf16_f32 v127, v190, v191
  v_pk_mul_f32 v[192:193], v[192:193], s[94:95]
  v_pk_mul_f32 v[194:195], v[194:195], s[94:95]
  v_pk_mul_f32 v[196:197], v[196:197], s[94:95]
  v_pk_mul_f32 v[198:199], v[198:199], s[94:95]
  v_pk_mul_f32 v[200:201], v[200:201], s[94:95]
  v_pk_mul_f32 v[202:203], v[202:203], s[94:95]
  v_pk_mul_f32 v[204:205], v[204:205], s[94:95]
  v_pk_mul_f32 v[206:207], v[206:207], s[94:95]
  v_cvt_pk_bf16_f32 v128, v192, v193
  v_cvt_pk_bf16_f32 v129, v194, v195
  v_cvt_pk_bf16_f32 v130, v196, v197
  v_cvt_pk_bf16_f32 v131, v198, v199
  v_cvt_pk_bf16_f32 v132, v200, v201
  v_cvt_pk_bf16_f32 v133, v202, v203
  v_cvt_pk_bf16_f32 v134, v204, v205
  v_cvt_pk_bf16_f32 v135, v206, v207
  v_pk_mul_f32 v[208:209], v[208:209], s[94:95]
  v_pk_mul_f32 v[210:211], v[210:211], s[94:95]
  v_pk_mul_f32 v[212:213], v[212:213], s[94:95]
  v_pk_mul_f32 v[214:215], v[214:215], s[94:95]
  v_pk_mul_f32 v[216:217], v[216:217], s[94:95]
  v_pk_mul_f32 v[218:219], v[218:219], s[94:95]
  v_pk_mul_f32 v[220:221], v[220:221], s[94:95]
  v_pk_mul_f32 v[222:223], v[222:223], s[94:95]
  v_cvt_pk_bf16_f32 v136, v208, v209
  v_cvt_pk_bf16_f32 v137, v210, v211
  v_cvt_pk_bf16_f32 v138, v212, v213
  v_cvt_pk_bf16_f32 v139, v214, v215
  v_cvt_pk_bf16_f32 v140, v216, v217
  v_cvt_pk_bf16_f32 v141, v218, v219
  v_cvt_pk_bf16_f32 v142, v220, v221
  v_cvt_pk_bf16_f32 v143, v222, v223
  v_pk_mul_f32 v[224:225], v[224:225], s[94:95]
  v_pk_mul_f32 v[226:227], v[226:227], s[94:95]
  v_pk_mul_f32 v[228:229], v[228:229], s[94:95]
  v_pk_mul_f32 v[230:231], v[230:231], s[94:95]
  v_pk_mul_f32 v[232:233], v[232:233], s[94:95]
  v_pk_mul_f32 v[234:235], v[234:235], s[94:95]
  v_pk_mul_f32 v[236:237], v[236:237], s[94:95]
  v_pk_mul_f32 v[238:239], v[238:239], s[94:95]
  v_cvt_pk_bf16_f32 v144, v224, v225
  v_cvt_pk_bf16_f32 v145, v226, v227
  v_cvt_pk_bf16_f32 v146, v228, v229
  v_cvt_pk_bf16_f32 v147, v230, v231
  v_cvt_pk_bf16_f32 v148, v232, v233
  v_cvt_pk_bf16_f32 v149, v234, v235
  v_cvt_pk_bf16_f32 v150, v236, v237
  v_cvt_pk_bf16_f32 v151, v238, v239
  v_pk_mul_f32 v[240:241], v[240:241], s[94:95]
  v_pk_mul_f32 v[242:243], v[242:243], s[94:95]
  v_pk_mul_f32 v[244:245], v[244:245], s[94:95]
  v_pk_mul_f32 v[246:247], v[246:247], s[94:95]
  v_pk_mul_f32 v[248:249], v[248:249], s[94:95]
  v_pk_mul_f32 v[250:251], v[250:251], s[94:95]
  v_pk_mul_f32 v[252:253], v[252:253], s[94:95]
  v_pk_mul_f32 v[254:255], v[254:255], s[94:95]
  v_cvt_pk_bf16_f32 v152, v240, v241
  v_cvt_pk_bf16_f32 v153, v242, v243
  v_cvt_pk_bf16_f32 v154, v244, v245
  v_cvt_pk_bf16_f32 v155, v246, v247
  v_cvt_pk_bf16_f32 v156, v248, v249
  v_cvt_pk_bf16_f32 v157, v250, v251
  v_cvt_pk_bf16_f32 v158, v252, v253
  v_cvt_pk_bf16_f32 v159, v254, v255
  v_mov_b32 v160, 0
  v_mov_b32 v161, 0
  v_mov_b32 v162, 0
  v_mov_b32 v163, 0
  v_mov_b32 v164, 0
  v_mov_b32 v165, 0
  v_mov_b32 v166, 0
  v_mov_b32 v167, 0
  v_mov_b32 v168, 0
  v_mov_b32 v169, 0
  v_mov_b32 v170, 0
  v_mov_b32 v171, 0
  v_mov_b32 v172, 0
  v_mov_b32 v173, 0
  v_mov_b32 v174, 0
  v_mov_b32 v175, 0
  v_mov_b32 v176, 0
  v_mov_b32 v177, 0
  v_mov_b32 v178, 0
  v_mov_b32 v179, 0
  v_mov_b32 v180, 0
  v_mov_b32 v181, 0
  v_mov_b32 v182, 0
  v_mov_b32 v183, 0
  v_mov_b32 v184, 0
  v_mov_b32 v185, 0
  v_mov_b32 v186, 0
  v_mov_b32 v187, 0
  v_mov_b32 v188, 0
  v_mov_b32 v189, 0
  v_mov_b32 v190, 0
  v_mov_b32 v191, 0
  v_mov_b32 v192, 0
  v_mov_b32 v193, 0
  v_mov_b32 v194, 0
  v_mov_b32 v195, 0
  v_mov_b32 v196, 0
  v_mov_b32 v197, 0
  v_mov_b32 v198, 0
  v_mov_b32 v199, 0
  v_mov_b32 v200, 0
  v_mov_b32 v201, 0
  v_mov_b32 v202, 0
  v_mov_b32 v203, 0
  v_mov_b32 v204, 0
  v_mov_b32 v205, 0
  v_mov_b32 v206, 0
  v_mov_b32 v207, 0
  v_mov_b32 v32, 0
  v_mov_b32 v33, 0
  v_mov_b32 v34, 0
  v_mov_b32 v35, 0
  v_mov_b32 v36, 0
  v_mov_b32 v37, 0
  s_mov_b32 s100, 0xfffe0000
  s_mov_b32 s101, 0x3f803f80
  s_add_u32 s46, s50, 0
  s_mov_b32 s45, 0xfffe0000
  s_add_u32 s44, s50, 98304
  s_waitcnt lgkmcnt(0)
  v_lshrrev_b32 v31, 3, v0
  v_and_b32 v1, 7, v0
  v_lshlrev_b32 v1, 7, v1
  v_lshl_add_u32 v31, v31, 10, v1
  s_lshr_b32 s12, s2, 3
  s_lshl_b32 s12, s12, 13
  s_lshl_b32 s13, s28, 20
  s_add_u32 s12, s12, s13
  s_cmp_eq_u32 s3, 0
  s_cselect_b32 s8, s60, s70
  s_cselect_b32 s9, s61, s71
  s_and_b32 s9, s9, 0xffff
  s_mov_b32 s10, 4194304
  s_mov_b32 s11, 0x20000
  v_mfma_f32_32x32x16_bf16 v[208:223], a[224:227], v[64:67], v[160:175]
  v_mfma_f32_32x32x16_bf16 v[208:223], a[228:231], v[68:71], v[208:223]
  v_mfma_f32_32x32x16_bf16 v[208:223], a[232:235], v[72:75], v[208:223]
  v_mfma_f32_32x32x16_bf16 v[208:223], a[236:239], v[76:79], v[208:223]
  v_mfma_f32_32x32x16_bf16 v[208:223], a[240:243], v[80:83], v[208:223]
  v_mfma_f32_32x32x16_bf16 v[208:223], a[244:247], v[84:87], v[208:223]
  v_mfma_f32_32x32x16_bf16 v[208:223], a[248:251], v[88:91], v[208:223]
  v_mfma_f32_32x32x16_bf16 v[208:223], a[252:255], v[92:95], v[208:223]
  s_nop 7
  s_waitcnt vmcnt(62)
  s_barrier
  ds_read_b64_tr_b16 a[192:193], v10 offset:0
  ds_read_b64_tr_b16 a[194:195], v10 offset:1024
  ds_read_b64_tr_b16 a[196:197], v11 offset:0
  ds_read_b64_tr_b16 a[198:199], v11 offset:1024
  v_max3_f32 v22, v208, v209, v210
  v_max3_f32 v23, v211, v212, v213
  v_max3_f32 v22, v22, v214, v215
  ds_read_b64_tr_b16 a[200:201], v12 offset:0
  ds_read_b64_tr_b16 a[202:203], v12 offset:1024
  v_max3_f32 v23, v23, v216, v217
  v_max3_f32 v22, v22, v218, v219
  v_max3_f32 v23, v23, v220, v221
  ds_read_b64_tr_b16 a[204:205], v13 offset:0
  ds_read_b64_tr_b16 a[206:207], v13 offset:1024
  v_max3_f32 v22, v22, v222, v223
  v_max_f32 v22, v22, v23
  v_cmp_lt_f32 vcc, s32, v22
  ds_read_b64_tr_b16 a[208:209], v10 offset:4096
  ds_read_b64_tr_b16 a[210:211], v10 offset:5120
  s_mov_b32 m0, s44
  s_cbranch_vccnz slow_p0
back_p0:
  v_exp_f32 v208, v208
  v_exp_f32 v209, v209
  ds_read_b64_tr_b16 a[212:213], v11 offset:4096
  v_exp_f32 v210, v210
  v_add_f32 v32, v32, v208
  v_add_f32 v33, v33, v209
  v_cvt_pk_bf16_f32 v40, v208, v209
  ds_read_b64_tr_b16 a[214:215], v11 offset:5120
  v_exp_f32 v211, v211
  v_exp_f32 v212, v212
  buffer_load_dwordx4 v18, s[20:23], s42 offen nt lds
  v_mfma_f32_32x32x16_bf16 v[224:239], a[224:227], v[96:99], v[176:191]
  v_exp_f32 v213, v213
  v_add_f32 v32, v32, v210
  v_add_f32 v33, v33, v211
  v_cvt_pk_bf16_f32 v41, v210, v211
  ds_read_b64_tr_b16 a[216:217], v12 offset:4096
  v_mfma_f32_32x32x16_bf16 v[224:239], a[228:231], v[100:103], v[224:239]
  v_exp_f32 v214, v214
  v_add_f32 v32, v32, v212
  v_add_f32 v33, v33, v213
  v_cvt_pk_bf16_f32 v42, v212, v213
  ds_read_b64_tr_b16 a[218:219], v12 offset:5120
  v_mfma_f32_32x32x16_bf16 v[224:239], a[232:235], v[104:107], v[224:239]
  v_exp_f32 v215, v215
  v_exp_f32 v216, v216
  ds_read_b64_tr_b16 a[220:221], v13 offset:4096
  ds_read_b64_tr_b16 a[222:223], v13 offset:5120
  v_mfma_f32_32x32x16_bf16 v[224:239], a[236:239], v[108:111], v[224:239]
  v_exp_f32 v217, v217
  v_add_f32 v32, v32, v214
  v_add_f32 v33, v33, v215
  v_cvt_pk_bf16_f32 v43, v214, v215
  v_add_u32 v10, s45, v10
  v_mfma_f32_32x32x16_bf16 v[224:239], a[240:243], v[112:115], v[224:239]
  v_exp_f32 v218, v218
  v_add_f32 v32, v32, v216
  v_add_f32 v33, v33, v217
  v_cvt_pk_bf16_f32 v44, v216, v217
  v_add_u32 v11, s45, v11
  v_mfma_f32_32x32x16_bf16 v[224:239], a[244:247], v[116:119], v[224:239]
  v_exp_f32 v219, v219
  v_exp_f32 v220, v220
  buffer_load_dwordx4 v18, s[20:23], s42 offen offset:1024 nt lds
  v_mfma_f32_32x32x16_bf16 v[224:239], a[248:251], v[120:123], v[224:239]
  v_exp_f32 v221, v221
  v_add_f32 v32, v32, v218
  v_add_f32 v33, v33, v219
  v_cvt_pk_bf16_f32 v45, v218, v219
  v_add_u32 v12, s45, v12
  v_mfma_f32_32x32x16_bf16 v[224:239], a[252:255], v[124:127], v[224:239]
  v_exp_f32 v222, v222
  v_add_f32 v32, v32, v220
  v_add_f32 v33, v33, v221
  v_cvt_pk_bf16_f32 v46, v220, v221
  s_waitcnt lgkmcnt(0)
  v_mfma_f32_32x32x16_bf16 a[0:15], a[192:195], v[40:43], a[0:15]
  v_exp_f32 v223, v223
  v_add_u32 v13, s45, v13
  buffer_load_dwordx4 v18, s[20:23], s42 offen offset:2048 nt lds
  v_mfma_f32_32x32x16_bf16 a[16:31], a[196:199], v[40:43], a[16:31]
  v_add_f32 v32, v32, v222
  v_add_f32 v33, v33, v223
  v_cvt_pk_bf16_f32 v47, v222, v223
  v_mfma_f32_32x32x16_bf16 a[32:47], a[200:203], v[40:43], a[32:47]
  v_max3_f32 v22, v224, v225, v226
  v_max3_f32 v23, v227, v228, v229
  v_max3_f32 v22, v22, v230, v231
  v_mfma_f32_32x32x16_bf16 a[48:63], a[204:207], v[40:43], a[48:63]
  v_max3_f32 v23, v23, v232, v233
  v_max3_f32 v22, v22, v234, v235
  v_max3_f32 v23, v23, v236, v237
  buffer_load_dwordx4 v18, s[20:23], s42 offen offset:3072 nt lds
  v_mfma_f32_32x32x16_bf16 a[0:15], a[208:211], v[44:47], a[0:15]
  v_max3_f32 v22, v22, v238, v239
  v_max_f32 v22, v22, v23
  v_cmp_lt_f32 vcc, s33, v22
  s_add_u32 s42, s42, 8192
  s_cmp_ge_u32 s42, 131072
  s_cselect_b32 s22, 0, 131072
  v_mfma_f32_32x32x16_bf16 a[16:31], a[212:215], v[44:47], a[16:31]
  s_cbranch_vccnz slow_p1
back_p1:
  v_exp_f32 v224, v224
  v_exp_f32 v225, v225
  v_mfma_f32_32x32x16_bf16 a[32:47], a[216:219], v[44:47], a[32:47]
  v_exp_f32 v226, v226
  v_add_f32 v34, v34, v224
  v_add_f32 v35, v35, v225
  v_cvt_pk_bf16_f32 v48, v224, v225
  v_mfma_f32_32x32x16_bf16 a[48:63], a[220:223], v[44:47], a[48:63]
  v_exp_f32 v227, v227
  v_exp_f32 v228, v228
  v_mfma_f32_32x32x16_bf16 v[240:255], a[224:227], v[128:131], v[192:207]
  v_exp_f32 v229, v229
  v_add_f32 v34, v34, v226
  v_add_f32 v35, v35, v227
  v_cvt_pk_bf16_f32 v49, v226, v227
  ds_read_b128 a[224:227], v2
  v_mfma_f32_32x32x16_bf16 v[240:255], a[228:231], v[132:135], v[240:255]
  v_exp_f32 v230, v230
  v_add_f32 v34, v34, v228
  v_add_f32 v35, v35, v229
  v_cvt_pk_bf16_f32 v50, v228, v229
  ds_read_b128 a[228:231], v3
  v_mfma_f32_32x32x16_bf16 v[240:255], a[232:235], v[136:139], v[240:255]
  v_exp_f32 v231, v231
  v_exp_f32 v232, v232
  ds_read_b128 a[232:235], v4
  v_mfma_f32_32x32x16_bf16 v[240:255], a[236:239], v[140:143], v[240:255]
  v_exp_f32 v233, v233
  v_add_f32 v34, v34, v230
  v_add_f32 v35, v35, v231
  v_cvt_pk_bf16_f32 v51, v230, v231
  ds_read_b128 a[236:239], v5
  v_mfma_f32_32x32x16_bf16 v[240:255], a[240:243], v[144:147], v[240:255]
  v_exp_f32 v234, v234
  v_add_f32 v34, v34, v232
  v_add_f32 v35, v35, v233
  v_cvt_pk_bf16_f32 v52, v232, v233
  ds_read_b128 a[240:243], v6
  v_mfma_f32_32x32x16_bf16 v[240:255], a[244:247], v[148:151], v[240:255]
  v_exp_f32 v235, v235
  v_exp_f32 v236, v236
  ds_read_b128 a[244:247], v7
  v_mfma_f32_32x32x16_bf16 v[240:255], a[248:251], v[152:155], v[240:255]
  v_exp_f32 v237, v237
  v_add_f32 v34, v34, v234
  v_add_f32 v35, v35, v235
  v_cvt_pk_bf16_f32 v53, v234, v235
  ds_read_b128 a[248:251], v8
  v_mfma_f32_32x32x16_bf16 v[240:255], a[252:255], v[156:159], v[240:255]
  v_exp_f32 v238, v238
  v_add_f32 v34, v34, v236
  v_add_f32 v35, v35, v237
  v_cvt_pk_bf16_f32 v54, v236, v237
  s_mov_b32 s47, 14
k1_aloop:
  s_cmp_eq_u32 s47, 1
  s_cbranch_scc1 k1_wot
k1_wot_ret:
  v_mfma_f32_32x32x16_bf16 a[64:79], a[192:195], v[48:51], a[64:79]
  v_exp_f32 v239, v239
  ds_read_b128 a[252:255], v9
  s_add_u32 m0, s44, 8192
  v_add_u32 v2, s45, v2
  v_add_u32 v3, s45, v3
  v_mfma_f32_32x32x16_bf16 a[80:95], a[196:199], v[48:51], a[80:95]
  v_add_f32 v34, v34, v238
  v_add_f32 v35, v35, v239
  v_cvt_pk_bf16_f32 v55, v238, v239
  buffer_load_dwordx4 v14, s[16:19], s43 offen nt lds
  v_add_u32 v4, s45, v4
  v_mfma_f32_32x32x16_bf16 a[96:111], a[200:203], v[48:51], a[96:111]
  v_max3_f32 v22, v240, v241, v242
  v_max3_f32 v23, v243, v244, v245
  v_max3_f32 v22, v22, v246, v247
  v_add_u32 v5, s45, v5
  v_add_u32 v6, s45, v6
  v_add_u32 v7, s45, v7
  v_mfma_f32_32x32x16_bf16 a[112:127], a[204:207], v[48:51], a[112:127]
  v_max3_f32 v23, v23, v248, v249
  v_max3_f32 v22, v22, v250, v251
  v_max3_f32 v23, v23, v252, v253
  v_add_u32 v8, s45, v8
  v_mfma_f32_32x32x16_bf16 a[64:79], a[208:211], v[52:55], a[64:79]
  v_max3_f32 v22, v22, v254, v255
  v_max_f32 v22, v22, v23
  v_cmp_lt_f32 vcc, s34, v22
  buffer_load_dwordx4 v15, s[16:19], s43 offen offset:1024 nt lds
  v_mfma_f32_32x32x16_bf16 a[80:95], a[212:215], v[52:55], a[80:95]
  s_cbranch_vccnz slow_a
back_a:
  v_exp_f32 v240, v240
  v_exp_f32 v241, v241
  v_mfma_f32_32x32x16_bf16 a[96:111], a[216:219], v[52:55], a[96:111]
  v_exp_f32 v242, v242
  v_add_f32 v36, v36, v240
  v_add_f32 v37, v37, v241
  v_cvt_pk_bf16_f32 v56, v240, v241
  v_mfma_f32_32x32x16_bf16 a[112:127], a[220:223], v[52:55], a[112:127]
  v_exp_f32 v243, v243
  v_exp_f32 v244, v244
  s_waitcnt lgkmcnt(0)
  v_add_u32 v9, s45, v9
  v_mfma_f32_32x32x16_bf16 v[208:223], a[224:227], v[64:67], v[160:175]
  v_exp_f32 v245, v245
  v_add_f32 v36, v36, v242
  v_add_f32 v37, v37, v243
  v_cvt_pk_bf16_f32 v57, v242, v243
  v_mfma_f32_32x32x16_bf16 v[208:223], a[228:231], v[68:71], v[208:223]
  v_exp_f32 v246, v246
  v_add_f32 v36, v36, v244
  v_add_f32 v37, v37, v245
  v_cvt_pk_bf16_f32 v58, v244, v245
  v_mfma_f32_32x32x16_bf16 v[208:223], a[232:235], v[72:75], v[208:223]
  v_exp_f32 v247, v247
  v_exp_f32 v248, v248
  buffer_load_dwordx4 v16, s[16:19], s43 offen offset:2048 nt lds
  v_mfma_f32_32x32x16_bf16 v[208:223], a[236:239], v[76:79], v[208:223]
  v_exp_f32 v249, v249
  v_add_f32 v36, v36, v246
  v_add_f32 v37, v37, v247
  v_cvt_pk_bf16_f32 v59, v246, v247
  v_mfma_f32_32x32x16_bf16 v[208:223], a[240:243], v[80:83], v[208:223]
  v_exp_f32 v250, v250
  v_add_f32 v36, v36, v248
  v_add_f32 v37, v37, v249
  v_cvt_pk_bf16_f32 v60, v248, v249
  v_mfma_f32_32x32x16_bf16 v[208:223], a[244:247], v[84:87], v[208:223]
  v_exp_f32 v251, v251
  v_exp_f32 v252, v252
  buffer_load_dwordx4 v17, s[16:19], s43 offen offset:3072 nt lds
  v_mfma_f32_32x32x16_bf16 v[208:223], a[248:251], v[88:91], v[208:223]
  v_exp_f32 v253, v253
  v_add_f32 v36, v36, v250
  v_add_f32 v37, v37, v251
  v_cvt_pk_bf16_f32 v61, v250, v251
  s_sub_u32 s44, s46, s45
  v_mfma_f32_32x32x16_bf16 v[208:223], a[252:255], v[92:95], v[208:223]
  v_exp_f32 v254, v254
  v_add_f32 v36, v36, v252
  v_add_f32 v37, v37, v253
  v_cvt_pk_bf16_f32 v62, v252, v253
  s_waitcnt vmcnt(24)
  s_barrier
  v_mfma_f32_32x32x16_bf16 a[128:143], a[192:195], v[56:59], a[128:143]
  v_exp_f32 v255, v255
  ds_read_b64_tr_b16 a[192:193], v10 offset:0
  ds_read_b64_tr_b16 a[194:195], v10 offset:1024
  s_cmp_eq_u32 s46, s51
  s_cselect_b32 s45, s100, 32768
  v_mfma_f32_32x32x16_bf16 a[144:159], a[196:199], v[56:59], a[144:159]
  v_add_f32 v36, v36, v254
  v_add_f32 v37, v37, v255
  v_cvt_pk_bf16_f32 v63, v254, v255
  ds_read_b64_tr_b16 a[196:197], v11 offset:0
  ds_read_b64_tr_b16 a[198:199], v11 offset:1024
  s_add_u32 s46, s46, s45
  v_mfma_f32_32x32x16_bf16 a[160:175], a[200:203], v[56:59], a[160:175]
  v_max3_f32 v22, v208, v209, v210
  v_max3_f32 v23, v211, v212, v213
  v_max3_f32 v22, v22, v214, v215
  ds_read_b64_tr_b16 a[200:201], v12 offset:0
  ds_read_b64_tr_b16 a[202:203], v12 offset:1024
  v_mfma_f32_32x32x16_bf16 a[176:191], a[204:207], v[56:59], a[176:191]
  v_max3_f32 v23, v23, v216, v217
  v_max3_f32 v22, v22, v218, v219
  v_max3_f32 v23, v23, v220, v221
  ds_read_b64_tr_b16 a[204:205], v13 offset:0
  ds_read_b64_tr_b16 a[206:207], v13 offset:1024
  v_mfma_f32_32x32x16_bf16 a[128:143], a[208:211], v[60:63], a[128:143]
  v_max3_f32 v22, v22, v222, v223
  v_max_f32 v22, v22, v23
  v_cmp_lt_f32 vcc, s32, v22
  ds_read_b64_tr_b16 a[208:209], v10 offset:4096
  ds_read_b64_tr_b16 a[210:211], v10 offset:5120
  s_mov_b32 m0, s44
  v_mfma_f32_32x32x16_bf16 a[144:159], a[212:215], v[60:63], a[144:159]
  s_cbranch_vccnz slow_b
back_b:
  v_exp_f32 v208, v208
  v_exp_f32 v209, v209
  ds_read_b64_tr_b16 a[212:213], v11 offset:4096
  v_mfma_f32_32x32x16_bf16 a[160:175], a[216:219], v[60:63], a[160:175]
  v_exp_f32 v210, v210
  v_add_f32 v32, v32, v208
  v_add_f32 v33, v33, v209
  v_cvt_pk_bf16_f32 v40, v208, v209
  ds_read_b64_tr_b16 a[214:215], v11 offset:5120
  v_mfma_f32_32x32x16_bf16 a[176:191], a[220:223], v[60:63], a[176:191]
  v_exp_f32 v211, v211
  v_exp_f32 v212, v212
  buffer_load_dwordx4 v18, s[20:23], s42 offen nt lds
  v_mfma_f32_32x32x16_bf16 v[224:239], a[224:227], v[96:99], v[176:191]
  v_exp_f32 v213, v213
  v_add_f32 v32, v32, v210
  v_add_f32 v33, v33, v211
  v_cvt_pk_bf16_f32 v41, v210, v211
  ds_read_b64_tr_b16 a[216:217], v12 offset:4096
  v_mfma_f32_32x32x16_bf16 v[224:239], a[228:231], v[100:103], v[224:239]
  v_exp_f32 v214, v214
  v_add_f32 v32, v32, v212
  v_add_f32 v33, v33, v213
  v_cvt_pk_bf16_f32 v42, v212, v213
  ds_read_b64_tr_b16 a[218:219], v12 offset:5120
  v_mfma_f32_32x32x16_bf16 v[224:239], a[232:235], v[104:107], v[224:239]
  v_exp_f32 v215, v215
  v_exp_f32 v216, v216
  ds_read_b64_tr_b16 a[220:221], v13 offset:4096
  ds_read_b64_tr_b16 a[222:223], v13 offset:5120
  v_mfma_f32_32x32x16_bf16 v[224:239], a[236:239], v[108:111], v[224:239]
  v_exp_f32 v217, v217
  v_add_f32 v32, v32, v214
  v_add_f32 v33, v33, v215
  v_cvt_pk_bf16_f32 v43, v214, v215
  v_add_u32 v10, s45, v10
  v_mfma_f32_32x32x16_bf16 v[224:239], a[240:243], v[112:115], v[224:239]
  v_exp_f32 v218, v218
  v_add_f32 v32, v32, v216
  v_add_f32 v33, v33, v217
  v_cvt_pk_bf16_f32 v44, v216, v217
  v_add_u32 v11, s45, v11
  v_mfma_f32_32x32x16_bf16 v[224:239], a[244:247], v[116:119], v[224:239]
  v_exp_f32 v219, v219
  v_exp_f32 v220, v220
  buffer_load_dwordx4 v18, s[20:23], s42 offen offset:1024 nt lds
  v_mfma_f32_32x32x16_bf16 v[224:239], a[248:251], v[120:123], v[224:239]
  v_exp_f32 v221, v221
  v_add_f32 v32, v32, v218
  v_add_f32 v33, v33, v219
  v_cvt_pk_bf16_f32 v45, v218, v219
  v_add_u32 v12, s45, v12
  v_mfma_f32_32x32x16_bf16 v[224:239], a[252:255], v[124:127], v[224:239]
  v_exp_f32 v222, v222
  v_add_f32 v32, v32, v220
  v_add_f32 v33, v33, v221
  v_cvt_pk_bf16_f32 v46, v220, v221
  s_waitcnt lgkmcnt(0)
  v_mfma_f32_32x32x16_bf16 a[0:15], a[192:195], v[40:43], a[0:15]
  v_exp_f32 v223, v223
  v_add_u32 v13, s45, v13
  buffer_load_dwordx4 v18, s[20:23], s42 offen offset:2048 nt lds
  v_mfma_f32_32x32x16_bf16 a[16:31], a[196:199], v[40:43], a[16:31]
  v_add_f32 v32, v32, v222
  v_add_f32 v33, v33, v223
  v_cvt_pk_bf16_f32 v47, v222, v223
  s_add_u32 s43, s43, 8192
  s_cmp_ge_u32 s43, 131072
  s_cselect_b32 s18, 0, 131072
  v_mfma_f32_32x32x16_bf16 a[32:47], a[200:203], v[40:43], a[32:47]
  v_max3_f32 v22, v224, v225, v226
  v_max3_f32 v23, v227, v228, v229
  v_max3_f32 v22, v22, v230, v231
  v_mfma_f32_32x32x16_bf16 a[48:63], a[204:207], v[40:43], a[48:63]
  v_max3_f32 v23, v23, v232, v233
  v_max3_f32 v22, v22, v234, v235
  v_max3_f32 v23, v23, v236, v237
  buffer_load_dwordx4 v18, s[20:23], s42 offen offset:3072 nt lds
  v_mfma_f32_32x32x16_bf16 a[0:15], a[208:211], v[44:47], a[0:15]
  v_max3_f32 v22, v22, v238, v239
  v_max_f32 v22, v22, v23
  v_cmp_lt_f32 vcc, s33, v22
  s_add_u32 s42, s42, 8192
  s_cmp_ge_u32 s42, 131072
  s_cselect_b32 s22, 0, 131072
  v_mfma_f32_32x32x16_bf16 a[16:31], a[212:215], v[44:47], a[16:31]
  s_cbranch_vccnz slow_c
back_c:
  v_exp_f32 v224, v224
  v_exp_f32 v225, v225
  v_mfma_f32_32x32x16_bf16 a[32:47], a[216:219], v[44:47], a[32:47]
  v_exp_f32 v226, v226
  v_add_f32 v34, v34, v224
  v_add_f32 v35, v35, v225
  v_cvt_pk_bf16_f32 v48, v224, v225
  v_mfma_f32_32x32x16_bf16 a[48:63], a[220:223], v[44:47], a[48:63]
  v_exp_f32 v227, v227
  v_exp_f32 v228, v228
  v_mfma_f32_32x32x16_bf16 v[240:255], a[224:227], v[128:131], v[192:207]
  v_exp_f32 v229, v229
  v_add_f32 v34, v34, v226
  v_add_f32 v35, v35, v227
  v_cvt_pk_bf16_f32 v49, v226, v227
  ds_read_b128 a[224:227], v2
  v_mfma_f32_32x32x16_bf16 v[240:255], a[228:231], v[132:135], v[240:255]
  v_exp_f32 v230, v230
  v_add_f32 v34, v34, v228
  v_add_f32 v35, v35, v229
  v_cvt_pk_bf16_f32 v50, v228, v229
  ds_read_b128 a[228:231], v3
  v_mfma_f32_32x32x16_bf16 v[240:255], a[232:235], v[136:139], v[240:255]
  v_exp_f32 v231, v231
  v_exp_f32 v232, v232
  ds_read_b128 a[232:235], v4
  v_mfma_f32_32x32x16_bf16 v[240:255], a[236:239], v[140:143], v[240:255]
  v_exp_f32 v233, v233
  v_add_f32 v34, v34, v230
  v_add_f32 v35, v35, v231
  v_cvt_pk_bf16_f32 v51, v230, v231
  ds_read_b128 a[236:239], v5
  v_mfma_f32_32x32x16_bf16 v[240:255], a[240:243], v[144:147], v[240:255]
  v_exp_f32 v234, v234
  v_add_f32 v34, v34, v232
  v_add_f32 v35, v35, v233
  v_cvt_pk_bf16_f32 v52, v232, v233
  ds_read_b128 a[240:243], v6
  v_mfma_f32_32x32x16_bf16 v[240:255], a[244:247], v[148:151], v[240:255]
  v_exp_f32 v235, v235
  v_exp_f32 v236, v236
  ds_read_b128 a[244:247], v7
  v_mfma_f32_32x32x16_bf16 v[240:255], a[248:251], v[152:155], v[240:255]
  v_exp_f32 v237, v237
  v_add_f32 v34, v34, v234
  v_add_f32 v35, v35, v235
  v_cvt_pk_bf16_f32 v53, v234, v235
  ds_read_b128 a[248:251], v8
  v_mfma_f32_32x32x16_bf16 v[240:255], a[252:255], v[156:159], v[240:255]
  v_exp_f32 v238, v238
  v_add_f32 v34, v34, v236
  v_add_f32 v35, v35, v237
  v_cvt_pk_bf16_f32 v54, v236, v237
  s_sub_u32 s47, s47, 1
  s_cbranch_scc0 k1_aloop
  v_mfma_f32_32x32x16_bf16 a[64:79], a[192:195], v[48:51], a[64:79]
  v_exp_f32 v239, v239
  v_mfma_f32_32x32x16_bf16 a[80:95], a[196:199], v[48:51], a[80:95]
  v_add_f32 v34, v34, v238
  v_add_f32 v35, v35, v239
  v_cvt_pk_bf16_f32 v55, v238, v239
  v_mfma_f32_32x32x16_bf16 a[96:111], a[200:203], v[48:51], a[96:111]
  v_max3_f32 v22, v240, v241, v242
  v_max3_f32 v23, v243, v244, v245
  v_max3_f32 v22, v22, v246, v247
  v_mfma_f32_32x32x16_bf16 a[112:127], a[204:207], v[48:51], a[112:127]
  v_max3_f32 v23, v23, v248, v249
  v_max3_f32 v22, v22, v250, v251
  v_max3_f32 v23, v23, v252, v253
  v_mfma_f32_32x32x16_bf16 a[64:79], a[208:211], v[52:55], a[64:79]
  v_max3_f32 v22, v22, v254, v255
  v_max_f32 v22, v22, v23
  v_cmp_lt_f32 vcc, s34, v22
  v_mfma_f32_32x32x16_bf16 a[80:95], a[212:215], v[52:55], a[80:95]
  s_cbranch_vccnz slow_e
back_e:
  v_exp_f32 v240, v240
  v_exp_f32 v241, v241
  v_mfma_f32_32x32x16_bf16 a[96:111], a[216:219], v[52:55], a[96:111]
  v_exp_f32 v242, v242
  v_add_f32 v36, v36, v240
  v_add_f32 v37, v37, v241
  v_cvt_pk_bf16_f32 v56, v240, v241
  v_mfma_f32_32x32x16_bf16 a[112:127], a[220:223], v[52:55], a[112:127]
  v_exp_f32 v243, v243
  v_exp_f32 v244, v244
  v_exp_f32 v245, v245
  v_add_f32 v36, v36, v242
  v_add_f32 v37, v37, v243
  v_cvt_pk_bf16_f32 v57, v242, v243
  v_exp_f32 v246, v246
  v_add_f32 v36, v36, v244
  v_add_f32 v37, v37, v245
  v_cvt_pk_bf16_f32 v58, v244, v245
  v_exp_f32 v247, v247
  v_exp_f32 v248, v248
  v_exp_f32 v249, v249
  v_add_f32 v36, v36, v246
  v_add_f32 v37, v37, v247
  v_cvt_pk_bf16_f32 v59, v246, v247
  v_exp_f32 v250, v250
  v_add_f32 v36, v36, v248
  v_add_f32 v37, v37, v249
  v_cvt_pk_bf16_f32 v60, v248, v249
  v_exp_f32 v251, v251
  v_exp_f32 v252, v252
  v_exp_f32 v253, v253
  v_add_f32 v36, v36, v250
  v_add_f32 v37, v37, v251
  v_cvt_pk_bf16_f32 v61, v250, v251
  v_exp_f32 v254, v254
  v_add_f32 v36, v36, v252
  v_add_f32 v37, v37, v253
  v_cvt_pk_bf16_f32 v62, v252, v253
  v_exp_f32 v255, v255
  s_nop 0
  v_add_f32 v36, v36, v254
  v_add_f32 v37, v37, v255
  v_cvt_pk_bf16_f32 v63, v254, v255
  s_nop 0
  s_nop 0
  s_nop 0
  s_nop 1
  v_mfma_f32_32x32x16_bf16 a[128:143], a[192:195], v[56:59], a[128:143]
  v_mfma_f32_32x32x16_bf16 a[144:159], a[196:199], v[56:59], a[144:159]
  v_mfma_f32_32x32x16_bf16 a[160:175], a[200:203], v[56:59], a[160:175]
  v_mfma_f32_32x32x16_bf16 a[176:191], a[204:207], v[56:59], a[176:191]
  v_mfma_f32_32x32x16_bf16 a[128:143], a[208:211], v[60:63], a[128:143]
  v_mfma_f32_32x32x16_bf16 a[144:159], a[212:215], v[60:63], a[144:159]
  v_mfma_f32_32x32x16_bf16 a[160:175], a[216:219], v[60:63], a[160:175]
  v_mfma_f32_32x32x16_bf16 a[176:191], a[220:223], v[60:63], a[176:191]
  v_add_f32 v19, v32, v33
  v_mov_b32 v25, v19
  s_nop 1
  v_permlane32_swap_b32 v25, v19
  s_nop 1
  v_add_f32 v25, v25, v19
  v_rcp_f32 v32, v25
  s_nop 0
  v_mov_b32 v33, v32
  v_add_f32 v20, v34, v35
  v_mov_b32 v25, v20
  s_nop 1
  v_permlane32_swap_b32 v25, v20
  s_nop 1
  v_add_f32 v25, v25, v20
  v_rcp_f32 v34, v25
  s_nop 0
  v_mov_b32 v35, v34
  v_add_f32 v21, v36, v37
  v_mov_b32 v25, v21
  s_nop 1
  v_permlane32_swap_b32 v25, v21
  s_nop 1
  v_add_f32 v25, v25, v21
  v_rcp_f32 v36, v25
  s_nop 0
  v_mov_b32 v37, v36
  s_nop 7
  v_accvgpr_read_b32 v64, a0
  v_accvgpr_read_b32 v65, a1
  v_accvgpr_read_b32 v66, a2
  v_accvgpr_read_b32 v67, a3
  v_accvgpr_read_b32 v68, a4
  v_accvgpr_read_b32 v69, a5
  v_accvgpr_read_b32 v70, a6
  v_accvgpr_read_b32 v71, a7
  v_pk_mul_f32 v[64:65], v[64:65], v[32:33]
  v_pk_mul_f32 v[66:67], v[66:67], v[32:33]
  v_pk_mul_f32 v[68:69], v[68:69], v[32:33]
  v_pk_mul_f32 v[70:71], v[70:71], v[32:33]
  v_cvt_pk_bf16_f32 v72, v64, v65
  v_cvt_pk_bf16_f32 v73, v66, v67
  v_cvt_pk_bf16_f32 v74, v68, v69
  v_cvt_pk_bf16_f32 v75, v70, v71
  s_mov_b32 s48, 0
  buffer_store_dwordx4 v[72:75], v24, s[24:27], s48 offen sc1
  v_accvgpr_read_b32 v76, a8
  v_accvgpr_read_b32 v77, a9
  v_accvgpr_read_b32 v78, a10
  v_accvgpr_read_b32 v79, a11
  v_accvgpr_read_b32 v80, a12
  v_accvgpr_read_b32 v81, a13
  v_accvgpr_read_b32 v82, a14
  v_accvgpr_read_b32 v83, a15
  v_pk_mul_f32 v[76:77], v[76:77], v[32:33]
  v_pk_mul_f32 v[78:79], v[78:79], v[32:33]
  v_pk_mul_f32 v[80:81], v[80:81], v[32:33]
  v_pk_mul_f32 v[82:83], v[82:83], v[32:33]
  v_cvt_pk_bf16_f32 v84, v76, v77
  v_cvt_pk_bf16_f32 v85, v78, v79
  v_cvt_pk_bf16_f32 v86, v80, v81
  v_cvt_pk_bf16_f32 v87, v82, v83
  s_mov_b32 s48, 1024
  buffer_store_dwordx4 v[84:87], v24, s[24:27], s48 offen sc1
  v_accvgpr_read_b32 v88, a16
  v_accvgpr_read_b32 v89, a17
  v_accvgpr_read_b32 v90, a18
  v_accvgpr_read_b32 v91, a19
  v_accvgpr_read_b32 v92, a20
  v_accvgpr_read_b32 v93, a21
  v_accvgpr_read_b32 v94, a22
  v_accvgpr_read_b32 v95, a23
  v_pk_mul_f32 v[88:89], v[88:89], v[32:33]
  v_pk_mul_f32 v[90:91], v[90:91], v[32:33]
  v_pk_mul_f32 v[92:93], v[92:93], v[32:33]
  v_pk_mul_f32 v[94:95], v[94:95], v[32:33]
  v_cvt_pk_bf16_f32 v96, v88, v89
  v_cvt_pk_bf16_f32 v97, v90, v91
  v_cvt_pk_bf16_f32 v98, v92, v93
  v_cvt_pk_bf16_f32 v99, v94, v95
  s_mov_b32 s48, 2048
  buffer_store_dwordx4 v[96:99], v24, s[24:27], s48 offen sc1
  v_accvgpr_read_b32 v100, a24
  v_accvgpr_read_b32 v101, a25
  v_accvgpr_read_b32 v102, a26
  v_accvgpr_read_b32 v103, a27
  v_accvgpr_read_b32 v104, a28
  v_accvgpr_read_b32 v105, a29
  v_accvgpr_read_b32 v106, a30
  v_accvgpr_read_b32 v107, a31
  v_pk_mul_f32 v[100:101], v[100:101], v[32:33]
  v_pk_mul_f32 v[102:103], v[102:103], v[32:33]
  v_pk_mul_f32 v[104:105], v[104:105], v[32:33]
  v_pk_mul_f32 v[106:107], v[106:107], v[32:33]
  v_cvt_pk_bf16_f32 v108, v100, v101
  v_cvt_pk_bf16_f32 v109, v102, v103
  v_cvt_pk_bf16_f32 v110, v104, v105
  v_cvt_pk_bf16_f32 v111, v106, v107
  s_mov_b32 s48, 3072
  buffer_store_dwordx4 v[108:111], v24, s[24:27], s48 offen sc1
  v_accvgpr_read_b32 v112, a32
  v_accvgpr_read_b32 v113, a33
  v_accvgpr_read_b32 v114, a34
  v_accvgpr_read_b32 v115, a35
  v_accvgpr_read_b32 v116, a36
  v_accvgpr_read_b32 v117, a37
  v_accvgpr_read_b32 v118, a38
  v_accvgpr_read_b32 v119, a39
  v_pk_mul_f32 v[112:113], v[112:113], v[32:33]
  v_pk_mul_f32 v[114:115], v[114:115], v[32:33]
  v_pk_mul_f32 v[116:117], v[116:117], v[32:33]
  v_pk_mul_f32 v[118:119], v[118:119], v[32:33]
  v_cvt_pk_bf16_f32 v120, v112, v113
  v_cvt_pk_bf16_f32 v121, v114, v115
  v_cvt_pk_bf16_f32 v122, v116, v117
  v_cvt_pk_bf16_f32 v123, v118, v119
  s_mov_b32 s48, 4096
  buffer_store_dwordx4 v[120:123], v24, s[24:27], s48 offen sc1
  v_accvgpr_read_b32 v124, a40
  v_accvgpr_read_b32 v125, a41
  v_accvgpr_read_b32 v126, a42
  v_accvgpr_read_b32 v127, a43
  v_accvgpr_read_b32 v128, a44
  v_accvgpr_read_b32 v129, a45
  v_accvgpr_read_b32 v130, a46
  v_accvgpr_read_b32 v131, a47
  v_pk_mul_f32 v[124:125], v[124:125], v[32:33]
  v_pk_mul_f32 v[126:127], v[126:127], v[32:33]
  v_pk_mul_f32 v[128:129], v[128:129], v[32:33]
  v_pk_mul_f32 v[130:131], v[130:131], v[32:33]
  v_cvt_pk_bf16_f32 v132, v124, v125
  v_cvt_pk_bf16_f32 v133, v126, v127
  v_cvt_pk_bf16_f32 v134, v128, v129
  v_cvt_pk_bf16_f32 v135, v130, v131
  s_mov_b32 s48, 5120
  buffer_store_dwordx4 v[132:135], v24, s[24:27], s48 offen sc1
  v_accvgpr_read_b32 v64, a48
  v_accvgpr_read_b32 v65, a49
  v_accvgpr_read_b32 v66, a50
  v_accvgpr_read_b32 v67, a51
  v_accvgpr_read_b32 v68, a52
  v_accvgpr_read_b32 v69, a53
  v_accvgpr_read_b32 v70, a54
  v_accvgpr_read_b32 v71, a55
  v_pk_mul_f32 v[64:65], v[64:65], v[32:33]
  v_pk_mul_f32 v[66:67], v[66:67], v[32:33]
  v_pk_mul_f32 v[68:69], v[68:69], v[32:33]
  v_pk_mul_f32 v[70:71], v[70:71], v[32:33]
  v_cvt_pk_bf16_f32 v72, v64, v65
  v_cvt_pk_bf16_f32 v73, v66, v67
  v_cvt_pk_bf16_f32 v74, v68, v69
  v_cvt_pk_bf16_f32 v75, v70, v71
  s_mov_b32 s48, 6144
  buffer_store_dwordx4 v[72:75], v24, s[24:27], s48 offen sc1
  v_accvgpr_read_b32 v76, a56
  v_accvgpr_read_b32 v77, a57
  v_accvgpr_read_b32 v78, a58
  v_accvgpr_read_b32 v79, a59
  v_accvgpr_read_b32 v80, a60
  v_accvgpr_read_b32 v81, a61
  v_accvgpr_read_b32 v82, a62
  v_accvgpr_read_b32 v83, a63
  v_pk_mul_f32 v[76:77], v[76:77], v[32:33]
  v_pk_mul_f32 v[78:79], v[78:79], v[32:33]
  v_pk_mul_f32 v[80:81], v[80:81], v[32:33]
  v_pk_mul_f32 v[82:83], v[82:83], v[32:33]
  v_cvt_pk_bf16_f32 v84, v76, v77
  v_cvt_pk_bf16_f32 v85, v78, v79
  v_cvt_pk_bf16_f32 v86, v80, v81
  v_cvt_pk_bf16_f32 v87, v82, v83
  s_mov_b32 s48, 7168
  buffer_store_dwordx4 v[84:87], v24, s[24:27], s48 offen sc1
  v_accvgpr_read_b32 v88, a64
  v_accvgpr_read_b32 v89, a65
  v_accvgpr_read_b32 v90, a66
  v_accvgpr_read_b32 v91, a67
  v_accvgpr_read_b32 v92, a68
  v_accvgpr_read_b32 v93, a69
  v_accvgpr_read_b32 v94, a70
  v_accvgpr_read_b32 v95, a71
  v_pk_mul_f32 v[88:89], v[88:89], v[34:35]
  v_pk_mul_f32 v[90:91], v[90:91], v[34:35]
  v_pk_mul_f32 v[92:93], v[92:93], v[34:35]
  v_pk_mul_f32 v[94:95], v[94:95], v[34:35]
  v_cvt_pk_bf16_f32 v96, v88, v89
  v_cvt_pk_bf16_f32 v97, v90, v91
  v_cvt_pk_bf16_f32 v98, v92, v93
  v_cvt_pk_bf16_f32 v99, v94, v95
  s_mov_b32 s48, 262144
  buffer_store_dwordx4 v[96:99], v24, s[24:27], s48 offen sc1
  v_accvgpr_read_b32 v100, a72
  v_accvgpr_read_b32 v101, a73
  v_accvgpr_read_b32 v102, a74
  v_accvgpr_read_b32 v103, a75
  v_accvgpr_read_b32 v104, a76
  v_accvgpr_read_b32 v105, a77
  v_accvgpr_read_b32 v106, a78
  v_accvgpr_read_b32 v107, a79
  v_pk_mul_f32 v[100:101], v[100:101], v[34:35]
  v_pk_mul_f32 v[102:103], v[102:103], v[34:35]
  v_pk_mul_f32 v[104:105], v[104:105], v[34:35]
  v_pk_mul_f32 v[106:107], v[106:107], v[34:35]
  v_cvt_pk_bf16_f32 v108, v100, v101
  v_cvt_pk_bf16_f32 v109, v102, v103
  v_cvt_pk_bf16_f32 v110, v104, v105
  v_cvt_pk_bf16_f32 v111, v106, v107
  s_mov_b32 s48, 263168
  buffer_store_dwordx4 v[108:111], v24, s[24:27], s48 offen sc1
  v_accvgpr_read_b32 v112, a80
  v_accvgpr_read_b32 v113, a81
  v_accvgpr_read_b32 v114, a82
  v_accvgpr_read_b32 v115, a83
  v_accvgpr_read_b32 v116, a84
  v_accvgpr_read_b32 v117, a85
  v_accvgpr_read_b32 v118, a86
  v_accvgpr_read_b32 v119, a87
  v_pk_mul_f32 v[112:113], v[112:113], v[34:35]
  v_pk_mul_f32 v[114:115], v[114:115], v[34:35]
  v_pk_mul_f32 v[116:117], v[116:117], v[34:35]
  v_pk_mul_f32 v[118:119], v[118:119], v[34:35]
  v_cvt_pk_bf16_f32 v120, v112, v113
  v_cvt_pk_bf16_f32 v121, v114, v115
  v_cvt_pk_bf16_f32 v122, v116, v117
  v_cvt_pk_bf16_f32 v123, v118, v119
  s_mov_b32 s48, 264192
  buffer_store_dwordx4 v[120:123], v24, s[24:27], s48 offen sc1
  v_accvgpr_read_b32 v124, a88
  v_accvgpr_read_b32 v125, a89
  v_accvgpr_read_b32 v126, a90
  v_accvgpr_read_b32 v127, a91
  v_accvgpr_read_b32 v128, a92
  v_accvgpr_read_b32 v129, a93
  v_accvgpr_read_b32 v130, a94
  v_accvgpr_read_b32 v131, a95
  v_pk_mul_f32 v[124:125], v[124:125], v[34:35]
  v_pk_mul_f32 v[126:127], v[126:127], v[34:35]
  v_pk_mul_f32 v[128:129], v[128:129], v[34:35]
  v_pk_mul_f32 v[130:131], v[130:131], v[34:35]
  v_cvt_pk_bf16_f32 v132, v124, v125
  v_cvt_pk_bf16_f32 v133, v126, v127
  v_cvt_pk_bf16_f32 v134, v128, v129
  v_cvt_pk_bf16_f32 v135, v130, v131
  s_mov_b32 s48, 265216
  buffer_store_dwordx4 v[132:135], v24, s[24:27], s48 offen sc1
  v_accvgpr_read_b32 v64, a96
  v_accvgpr_read_b32 v65, a97
  v_accvgpr_read_b32 v66, a98
  v_accvgpr_read_b32 v67, a99
  v_accvgpr_read_b32 v68, a100
  v_accvgpr_read_b32 v69, a101
  v_accvgpr_read_b32 v70, a102
  v_accvgpr_read_b32 v71, a103
  v_pk_mul_f32 v[64:65], v[64:65], v[34:35]
  v_pk_mul_f32 v[66:67], v[66:67], v[34:35]
  v_pk_mul_f32 v[68:69], v[68:69], v[34:35]
  v_pk_mul_f32 v[70:71], v[70:71], v[34:35]
  v_cvt_pk_bf16_f32 v72, v64, v65
  v_cvt_pk_bf16_f32 v73, v66, v67
  v_cvt_pk_bf16_f32 v74, v68, v69
  v_cvt_pk_bf16_f32 v75, v70, v71
  s_mov_b32 s48, 266240
  buffer_store_dwordx4 v[72:75], v24, s[24:27], s48 offen sc1
  v_accvgpr_read_b32 v76, a104
  v_accvgpr_read_b32 v77, a105
  v_accvgpr_read_b32 v78, a106
  v_accvgpr_read_b32 v79, a107
  v_accvgpr_read_b32 v80, a108
  v_accvgpr_read_b32 v81, a109
  v_accvgpr_read_b32 v82, a110
  v_accvgpr_read_b32 v83, a111
  v_pk_mul_f32 v[76:77], v[76:77], v[34:35]
  v_pk_mul_f32 v[78:79], v[78:79], v[34:35]
  v_pk_mul_f32 v[80:81], v[80:81], v[34:35]
  v_pk_mul_f32 v[82:83], v[82:83], v[34:35]
  v_cvt_pk_bf16_f32 v84, v76, v77
  v_cvt_pk_bf16_f32 v85, v78, v79
  v_cvt_pk_bf16_f32 v86, v80, v81
  v_cvt_pk_bf16_f32 v87, v82, v83
  s_mov_b32 s48, 267264
  buffer_store_dwordx4 v[84:87], v24, s[24:27], s48 offen sc1
  v_accvgpr_read_b32 v88, a112
  v_accvgpr_read_b32 v89, a113
  v_accvgpr_read_b32 v90, a114
  v_accvgpr_read_b32 v91, a115
  v_accvgpr_read_b32 v92, a116
  v_accvgpr_read_b32 v93, a117
  v_accvgpr_read_b32 v94, a118
  v_accvgpr_read_b32 v95, a119
  v_pk_mul_f32 v[88:89], v[88:89], v[34:35]
  v_pk_mul_f32 v[90:91], v[90:91], v[34:35]
  v_pk_mul_f32 v[92:93], v[92:93], v[34:35]
  v_pk_mul_f32 v[94:95], v[94:95], v[34:35]
  v_cvt_pk_bf16_f32 v96, v88, v89
  v_cvt_pk_bf16_f32 v97, v90, v91
  v_cvt_pk_bf16_f32 v98, v92, v93
  v_cvt_pk_bf16_f32 v99, v94, v95
  s_mov_b32 s48, 268288
  buffer_store_dwordx4 v[96:99], v24, s[24:27], s48 offen sc1
  v_accvgpr_read_b32 v100, a120
  v_accvgpr_read_b32 v101, a121
  v_accvgpr_read_b32 v102, a122
  v_accvgpr_read_b32 v103, a123
  v_accvgpr_read_b32 v104, a124
  v_accvgpr_read_b32 v105, a125
  v_accvgpr_read_b32 v106, a126
  v_accvgpr_read_b32 v107, a127
  v_pk_mul_f32 v[100:101], v[100:101], v[34:35]
  v_pk_mul_f32 v[102:103], v[102:103], v[34:35]
  v_pk_mul_f32 v[104:105], v[104:105], v[34:35]
  v_pk_mul_f32 v[106:107], v[106:107], v[34:35]
  v_cvt_pk_bf16_f32 v108, v100, v101
  v_cvt_pk_bf16_f32 v109, v102, v103
  v_cvt_pk_bf16_f32 v110, v104, v105
  v_cvt_pk_bf16_f32 v111, v106, v107
  s_mov_b32 s48, 269312
  buffer_store_dwordx4 v[108:111], v24, s[24:27], s48 offen sc1
  v_accvgpr_read_b32 v112, a128
  v_accvgpr_read_b32 v113, a129
  v_accvgpr_read_b32 v114, a130
  v_accvgpr_read_b32 v115, a131
  v_accvgpr_read_b32 v116, a132
  v_accvgpr_read_b32 v117, a133
  v_accvgpr_read_b32 v118, a134
  v_accvgpr_read_b32 v119, a135
  v_pk_mul_f32 v[112:113], v[112:113], v[36:37]
  v_pk_mul_f32 v[114:115], v[114:115], v[36:37]
  v_pk_mul_f32 v[116:117], v[116:117], v[36:37]
  v_pk_mul_f32 v[118:119], v[118:119], v[36:37]
  v_cvt_pk_bf16_f32 v120, v112, v113
  v_cvt_pk_bf16_f32 v121, v114, v115
  v_cvt_pk_bf16_f32 v122, v116, v117
  v_cvt_pk_bf16_f32 v123, v118, v119
  s_mov_b32 s48, 524288
  buffer_store_dwordx4 v[120:123], v24, s[24:27], s48 offen sc1
  v_accvgpr_read_b32 v124, a136
  v_accvgpr_read_b32 v125, a137
  v_accvgpr_read_b32 v126, a138
  v_accvgpr_read_b32 v127, a139
  v_accvgpr_read_b32 v128, a140
  v_accvgpr_read_b32 v129, a141
  v_accvgpr_read_b32 v130, a142
  v_accvgpr_read_b32 v131, a143
  v_pk_mul_f32 v[124:125], v[124:125], v[36:37]
  v_pk_mul_f32 v[126:127], v[126:127], v[36:37]
  v_pk_mul_f32 v[128:129], v[128:129], v[36:37]
  v_pk_mul_f32 v[130:131], v[130:131], v[36:37]
  v_cvt_pk_bf16_f32 v132, v124, v125
  v_cvt_pk_bf16_f32 v133, v126, v127
  v_cvt_pk_bf16_f32 v134, v128, v129
  v_cvt_pk_bf16_f32 v135, v130, v131
  s_mov_b32 s48, 525312
  buffer_store_dwordx4 v[132:135], v24, s[24:27], s48 offen sc1
  v_accvgpr_read_b32 v64, a144
  v_accvgpr_read_b32 v65, a145
  v_accvgpr_read_b32 v66, a146
  v_accvgpr_read_b32 v67, a147
  v_accvgpr_read_b32 v68, a148
  v_accvgpr_read_b32 v69, a149
  v_accvgpr_read_b32 v70, a150
  v_accvgpr_read_b32 v71, a151
  v_pk_mul_f32 v[64:65], v[64:65], v[36:37]
  v_pk_mul_f32 v[66:67], v[66:67], v[36:37]
  v_pk_mul_f32 v[68:69], v[68:69], v[36:37]
  v_pk_mul_f32 v[70:71], v[70:71], v[36:37]
  v_cvt_pk_bf16_f32 v72, v64, v65
  v_cvt_pk_bf16_f32 v73, v66, v67
  v_cvt_pk_bf16_f32 v74, v68, v69
  v_cvt_pk_bf16_f32 v75, v70, v71
  s_mov_b32 s48, 526336
  buffer_store_dwordx4 v[72:75], v24, s[24:27], s48 offen sc1
  v_accvgpr_read_b32 v76, a152
  v_accvgpr_read_b32 v77, a153
  v_accvgpr_read_b32 v78, a154
  v_accvgpr_read_b32 v79, a155
  v_accvgpr_read_b32 v80, a156
  v_accvgpr_read_b32 v81, a157
  v_accvgpr_read_b32 v82, a158
  v_accvgpr_read_b32 v83, a159
  v_pk_mul_f32 v[76:77], v[76:77], v[36:37]
  v_pk_mul_f32 v[78:79], v[78:79], v[36:37]
  v_pk_mul_f32 v[80:81], v[80:81], v[36:37]
  v_pk_mul_f32 v[82:83], v[82:83], v[36:37]
  v_cvt_pk_bf16_f32 v84, v76, v77
  v_cvt_pk_bf16_f32 v85, v78, v79
  v_cvt_pk_bf16_f32 v86, v80, v81
  v_cvt_pk_bf16_f32 v87, v82, v83
  s_mov_b32 s48, 527360
  buffer_store_dwordx4 v[84:87], v24, s[24:27], s48 offen sc1
  v_accvgpr_read_b32 v88, a160
  v_accvgpr_read_b32 v89, a161
  v_accvgpr_read_b32 v90, a162
  v_accvgpr_read_b32 v91, a163
  v_accvgpr_read_b32 v92, a164
  v_accvgpr_read_b32 v93, a165
  v_accvgpr_read_b32 v94, a166
  v_accvgpr_read_b32 v95, a167
  v_pk_mul_f32 v[88:89], v[88:89], v[36:37]
  v_pk_mul_f32 v[90:91], v[90:91], v[36:37]
  v_pk_mul_f32 v[92:93], v[92:93], v[36:37]
  v_pk_mul_f32 v[94:95], v[94:95], v[36:37]
  v_cvt_pk_bf16_f32 v96, v88, v89
  v_cvt_pk_bf16_f32 v97, v90, v91
  v_cvt_pk_bf16_f32 v98, v92, v93
  v_cvt_pk_bf16_f32 v99, v94, v95
  s_mov_b32 s48, 528384
  buffer_store_dwordx4 v[96:99], v24, s[24:27], s48 offen sc1
  v_accvgpr_read_b32 v100, a168
  v_accvgpr_read_b32 v101, a169
  v_accvgpr_read_b32 v102, a170
  v_accvgpr_read_b32 v103, a171
  v_accvgpr_read_b32 v104, a172
  v_accvgpr_read_b32 v105, a173
  v_accvgpr_read_b32 v106, a174
  v_accvgpr_read_b32 v107, a175
  v_pk_mul_f32 v[100:101], v[100:101], v[36:37]
  v_pk_mul_f32 v[102:103], v[102:103], v[36:37]
  v_pk_mul_f32 v[104:105], v[104:105], v[36:37]
  v_pk_mul_f32 v[106:107], v[106:107], v[36:37]
  v_cvt_pk_bf16_f32 v108, v100, v101
  v_cvt_pk_bf16_f32 v109, v102, v103
  v_cvt_pk_bf16_f32 v110, v104, v105
  v_cvt_pk_bf16_f32 v111, v106, v107
  s_mov_b32 s48, 529408
  buffer_store_dwordx4 v[108:111], v24, s[24:27], s48 offen sc1
  v_accvgpr_read_b32 v112, a176
  v_accvgpr_read_b32 v113, a177
  v_accvgpr_read_b32 v114, a178
  v_accvgpr_read_b32 v115, a179
  v_accvgpr_read_b32 v116, a180
  v_accvgpr_read_b32 v117, a181
  v_accvgpr_read_b32 v118, a182
  v_accvgpr_read_b32 v119, a183
  v_pk_mul_f32 v[112:113], v[112:113], v[36:37]
  v_pk_mul_f32 v[114:115], v[114:115], v[36:37]
  v_pk_mul_f32 v[116:117], v[116:117], v[36:37]
  v_pk_mul_f32 v[118:119], v[118:119], v[36:37]
  v_cvt_pk_bf16_f32 v120, v112, v113
  v_cvt_pk_bf16_f32 v121, v114, v115
  v_cvt_pk_bf16_f32 v122, v116, v117
  v_cvt_pk_bf16_f32 v123, v118, v119
  s_mov_b32 s48, 530432
  buffer_store_dwordx4 v[120:123], v24, s[24:27], s48 offen sc1
  v_accvgpr_read_b32 v124, a184
  v_accvgpr_read_b32 v125, a185
  v_accvgpr_read_b32 v126, a186
  v_accvgpr_read_b32 v127, a187
  v_accvgpr_read_b32 v128, a188
  v_accvgpr_read_b32 v129, a189
  v_accvgpr_read_b32 v130, a190
  v_accvgpr_read_b32 v131, a191
  v_pk_mul_f32 v[124:125], v[124:125], v[36:37]
  v_pk_mul_f32 v[126:127], v[126:127], v[36:37]
  v_pk_mul_f32 v[128:129], v[128:129], v[36:37]
  v_pk_mul_f32 v[130:131], v[130:131], v[36:37]
  v_cvt_pk_bf16_f32 v132, v124, v125
  v_cvt_pk_bf16_f32 v133, v126, v127
  v_cvt_pk_bf16_f32 v134, v128, v129
  v_cvt_pk_bf16_f32 v135, v130, v131
  s_mov_b32 s48, 531456
  buffer_store_dwordx4 v[132:135], v24, s[24:27], s48 offen sc1
  s_waitcnt vmcnt(0)
k1_end:
  s_endpgm
k1_wot:
  buffer_load_dword v1, v31, s[8:11], s12 offen
  s_add_u32 s12, s12, 262144
  buffer_load_dword v1, v31, s[8:11], s12 offen
  s_add_u32 s12, s12, 262144
  buffer_load_dword v1, v31, s[8:11], s12 offen
  s_add_u32 s12, s12, 262144
  buffer_load_dword v1, v31, s[8:11], s12 offen
  s_add_u32 s12, s12, 262144
  s_branch k1_wot_ret
slow_p0:
  v_mov_b32 v25, v22
  s_nop 1
  v_permlane32_swap_b32 v25, v22
  s_nop 1
  v_max_f32 v25, v25, v22
  v_max_f32 v25, s35, v25
  v_sub_f32 v208, v208, v25
  v_sub_f32 v209, v209, v25
  v_sub_f32 v210, v210, v25
  v_sub_f32 v211, v211, v25
  v_sub_f32 v212, v212, v25
  v_sub_f32 v213, v213, v25
  v_sub_f32 v214, v214, v25
  v_sub_f32 v215, v215, v25
  v_sub_f32 v216, v216, v25
  v_sub_f32 v217, v217, v25
  v_sub_f32 v218, v218, v25
  v_sub_f32 v219, v219, v25
  v_sub_f32 v220, v220, v25
  v_sub_f32 v221, v221, v25
  v_sub_f32 v222, v222, v25
  v_sub_f32 v223, v223, v25
  v_sub_f32 v160, v160, v25
  v_sub_f32 v161, v161, v25
  v_sub_f32 v162, v162, v25
  v_sub_f32 v163, v163, v25
  v_sub_f32 v164, v164, v25
  v_sub_f32 v165, v165, v25
  v_sub_f32 v166, v166, v25
  v_sub_f32 v167, v167, v25
  v_sub_f32 v168, v168, v25
  v_sub_f32 v169, v169, v25
  v_sub_f32 v170, v170, v25
  v_sub_f32 v171, v171, v25
  v_sub_f32 v172, v172, v25
  v_sub_f32 v173, v173, v25
  v_sub_f32 v174, v174, v25
  v_sub_f32 v175, v175, v25
  s_cmp_lg_u32 s35, 0
  s_cbranch_scc1 slowx_p0
  v_sub_f32 v26, 0, v25
  v_exp_f32 v26, v26
  s_nop 7
  s_nop 7
  v_mul_f32 v32, v32, v26
  v_mul_f32 v33, v33, v26
  v_accvgpr_read_b32 v27, a0
  v_mul_f32 v27, v27, v26
  v_accvgpr_write_b32 a0, v27
  v_accvgpr_read_b32 v28, a1
  v_mul_f32 v28, v28, v26
  v_accvgpr_write_b32 a1, v28
  v_accvgpr_read_b32 v29, a2
  v_mul_f32 v29, v29, v26
  v_accvgpr_write_b32 a2, v29
  v_accvgpr_read_b32 v30, a3
  v_mul_f32 v30, v30, v26
  v_accvgpr_write_b32 a3, v30
  v_accvgpr_read_b32 v27, a4
  v_mul_f32 v27, v27, v26
  v_accvgpr_write_b32 a4, v27
  v_accvgpr_read_b32 v28, a5
  v_mul_f32 v28, v28, v26
  v_accvgpr_write_b32 a5, v28
  v_accvgpr_read_b32 v29, a6
  v_mul_f32 v29, v29, v26
  v_accvgpr_write_b32 a6, v29
  v_accvgpr_read_b32 v30, a7
  v_mul_f32 v30, v30, v26
  v_accvgpr_write_b32 a7, v30
  v_accvgpr_read_b32 v27, a8
  v_mul_f32 v27, v27, v26
  v_accvgpr_write_b32 a8, v27
  v_accvgpr_read_b32 v28, a9
  v_mul_f32 v28, v28, v26
  v_accvgpr_write_b32 a9, v28
  v_accvgpr_read_b32 v29, a10
  v_mul_f32 v29, v29, v26
  v_accvgpr_write_b32 a10, v29
  v_accvgpr_read_b32 v30, a11
  v_mul_f32 v30, v30, v26
  v_accvgpr_write_b32 a11, v30
  v_accvgpr_read_b32 v27, a12
  v_mul_f32 v27, v27, v26
  v_accvgpr_write_b32 a12, v27
  v_accvgpr_read_b32 v28, a13
  v_mul_f32 v28, v28, v26
  v_accvgpr_write_b32 a13, v28
  v_accvgpr_read_b32 v29, a14
  v_mul_f32 v29, v29, v26
  v_accvgpr_write_b32 a14, v29
  v_accvgpr_read_b32 v30, a15
  v_mul_f32 v30, v30, v26
  v_accvgpr_write_b32 a15, v30
  v_accvgpr_read_b32 v27, a16
  v_mul_f32 v27, v27, v26
  v_accvgpr_write_b32 a16, v27
  v_accvgpr_read_b32 v28, a17
  v_mul_f32 v28, v28, v26
  v_accvgpr_write_b32 a17, v28
  v_accvgpr_read_b32 v29, a18
  v_mul_f32 v29, v29, v26
  v_accvgpr_write_b32 a18, v29
  v_accvgpr_read_b32 v30, a19
  v_mul_f32 v30, v30, v26
  v_accvgpr_write_b32 a19, v30
  v_accvgpr_read_b32 v27, a20
  v_mul_f32 v27, v27, v26
  v_accvgpr_write_b32 a20, v27
  v_accvgpr_read_b32 v28, a21
  v_mul_f32 v28, v28, v26
  v_accvgpr_write_b32 a21, v28
  v_accvgpr_read_b32 v29, a22
  v_mul_f32 v29, v29, v26
  v_accvgpr_write_b32 a22, v29
  v_accvgpr_read_b32 v30, a23
  v_mul_f32 v30, v30, v26
  v_accvgpr_write_b32 a23, v30
  v_accvgpr_read_b32 v27, a24
  v_mul_f32 v27, v27, v26
  v_accvgpr_write_b32 a24, v27
  v_accvgpr_read_b32 v28, a25
  v_mul_f32 v28, v28, v26
  v_accvgpr_write_b32 a25, v28
  v_accvgpr_read_b32 v29, a26
  v_mul_f32 v29, v29, v26
  v_accvgpr_write_b32 a26, v29
  v_accvgpr_read_b32 v30, a27
  v_mul_f32 v30, v30, v26
  v_accvgpr_write_b32 a27, v30
  v_accvgpr_read_b32 v27, a28
  v_mul_f32 v27, v27, v26
  v_accvgpr_write_b32 a28, v27
  v_accvgpr_read_b32 v28, a29
  v_mul_f32 v28, v28, v26
  v_accvgpr_write_b32 a29, v28
  v_accvgpr_read_b32 v29, a30
  v_mul_f32 v29, v29, v26
  v_accvgpr_write_b32 a30, v29
  v_accvgpr_read_b32 v30, a31
  v_mul_f32 v30, v30, v26
  v_accvgpr_write_b32 a31, v30
  v_accvgpr_read_b32 v27, a32
  v_mul_f32 v27, v27, v26
  v_accvgpr_write_b32 a32, v27
  v_accvgpr_read_b32 v28, a33
  v_mul_f32 v28, v28, v26
  v_accvgpr_write_b32 a33, v28
  v_accvgpr_read_b32 v29, a34
  v_mul_f32 v29, v29, v26
  v_accvgpr_write_b32 a34, v29
  v_accvgpr_read_b32 v30, a35
  v_mul_f32 v30, v30, v26
  v_accvgpr_write_b32 a35, v30
  v_accvgpr_read_b32 v27, a36
  v_mul_f32 v27, v27, v26
  v_accvgpr_write_b32 a36, v27
  v_accvgpr_read_b32 v28, a37
  v_mul_f32 v28, v28, v26
  v_accvgpr_write_b32 a37, v28
  v_accvgpr_read_b32 v29, a38
  v_mul_f32 v29, v29, v26
  v_accvgpr_write_b32 a38, v29
  v_accvgpr_read_b32 v30, a39
  v_mul_f32 v30, v30, v26
  v_accvgpr_write_b32 a39, v30
  v_accvgpr_read_b32 v27, a40
  v_mul_f32 v27, v27, v26
  v_accvgpr_write_b32 a40, v27
  v_accvgpr_read_b32 v28, a41
  v_mul_f32 v28, v28, v26
  v_accvgpr_write_b32 a41, v28
  v_accvgpr_read_b32 v29, a42
  v_mul_f32 v29, v29, v26
  v_accvgpr_write_b32 a42, v29
  v_accvgpr_read_b32 v30, a43
  v_mul_f32 v30, v30, v26
  v_accvgpr_write_b32 a43, v30
  v_accvgpr_read_b32 v27, a44
  v_mul_f32 v27, v27, v26
  v_accvgpr_write_b32 a44, v27
  v_accvgpr_read_b32 v28, a45
  v_mul_f32 v28, v28, v26
  v_accvgpr_write_b32 a45, v28
  v_accvgpr_read_b32 v29, a46
  v_mul_f32 v29, v29, v26
  v_accvgpr_write_b32 a46, v29
  v_accvgpr_read_b32 v30, a47
  v_mul_f32 v30, v30, v26
  v_accvgpr_write_b32 a47, v30
  v_accvgpr_read_b32 v27, a48
  v_mul_f32 v27, v27, v26
  v_accvgpr_write_b32 a48, v27
  v_accvgpr_read_b32 v28, a49
  v_mul_f32 v28, v28, v26
  v_accvgpr_write_b32 a49, v28
  v_accvgpr_read_b32 v29, a50
  v_mul_f32 v29, v29, v26
  v_accvgpr_write_b32 a50, v29
  v_accvgpr_read_b32 v30, a51
  v_mul_f32 v30, v30, v26
  v_accvgpr_write_b32 a51, v30
  v_accvgpr_read_b32 v27, a52
  v_mul_f32 v27, v27, v26
  v_accvgpr_write_b32 a52, v27
  v_accvgpr_read_b32 v28, a53
  v_mul_f32 v28, v28, v26
  v_accvgpr_write_b32 a53, v28
  v_accvgpr_read_b32 v29, a54
  v_mul_f32 v29, v29, v26
  v_accvgpr_write_b32 a54, v29
  v_accvgpr_read_b32 v30, a55
  v_mul_f32 v30, v30, v26
  v_accvgpr_write_b32 a55, v30
  v_accvgpr_read_b32 v27, a56
  v_mul_f32 v27, v27, v26
  v_accvgpr_write_b32 a56, v27
  v_accvgpr_read_b32 v28, a57
  v_mul_f32 v28, v28, v26
  v_accvgpr_write_b32 a57, v28
  v_accvgpr_read_b32 v29, a58
  v_mul_f32 v29, v29, v26
  v_accvgpr_write_b32 a58, v29
  v_accvgpr_read_b32 v30, a59
  v_mul_f32 v30, v30, v26
  v_accvgpr_write_b32 a59, v30
  v_accvgpr_read_b32 v27, a60
  v_mul_f32 v27, v27, v26
  v_accvgpr_write_b32 a60, v27
  v_accvgpr_read_b32 v28, a61
  v_mul_f32 v28, v28, v26
  v_accvgpr_write_b32 a61, v28
  v_accvgpr_read_b32 v29, a62
  v_mul_f32 v29, v29, v26
  v_accvgpr_write_b32 a62, v29
  v_accvgpr_read_b32 v30, a63
  v_mul_f32 v30, v30, v26
  v_accvgpr_write_b32 a63, v30
slowx_p0:
  s_mov_b32 s32, 0x41000000
  s_mov_b32 s35, 0
  s_nop 1
  s_branch back_p0
slow_p1:
  v_mov_b32 v25, v22
  s_nop 1
  v_permlane32_swap_b32 v25, v22
  s_nop 1
  v_max_f32 v25, v25, v22
  v_max_f32 v25, s36, v25
  v_sub_f32 v224, v224, v25
  v_sub_f32 v225, v225, v25
  v_sub_f32 v226, v226, v25
  v_sub_f32 v227, v227, v25
  v_sub_f32 v228, v228, v25
  v_sub_f32 v229, v229, v25
  v_sub_f32 v230, v230, v25
  v_sub_f32 v231, v231, v25
  v_sub_f32 v232, v232, v25
  v_sub_f32 v233, v233, v25
  v_sub_f32 v234, v234, v25
  v_sub_f32 v235, v235, v25
  v_sub_f32 v236, v236, v25
  v_sub_f32 v237, v237, v25
  v_sub_f32 v238, v238, v25
  v_sub_f32 v239, v239, v25
  v_sub_f32 v176, v176, v25
  v_sub_f32 v177, v177, v25
  v_sub_f32 v178, v178, v25
  v_sub_f32 v179, v179, v25
  v_sub_f32 v180, v180, v25
  v_sub_f32 v181, v181, v25
  v_sub_f32 v182, v182, v25
  v_sub_f32 v183, v183, v25
  v_sub_f32 v184, v184, v25
  v_sub_f32 v185, v185, v25
  v_sub_f32 v186, v186, v25
  v_sub_f32 v187, v187, v25
  v_sub_f32 v188, v188, v25
  v_sub_f32 v189, v189, v25
  v_sub_f32 v190, v190, v25
  v_sub_f32 v191, v191, v25
  s_cmp_lg_u32 s36, 0
  s_cbranch_scc1 slowx_p1
  v_sub_f32 v26, 0, v25
  v_exp_f32 v26, v26
  s_nop 7
  s_nop 7
  v_mul_f32 v34, v34, v26
  v_mul_f32 v35, v35, v26
  v_accvgpr_read_b32 v27, a64
  v_mul_f32 v27, v27, v26
  v_accvgpr_write_b32 a64, v27
  v_accvgpr_read_b32 v28, a65
  v_mul_f32 v28, v28, v26
  v_accvgpr_write_b32 a65, v28
  v_accvgpr_read_b32 v29, a66
  v_mul_f32 v29, v29, v26
  v_accvgpr_write_b32 a66, v29
  v_accvgpr_read_b32 v30, a67
  v_mul_f32 v30, v30, v26
  v_accvgpr_write_b32 a67, v30
  v_accvgpr_read_b32 v27, a68
  v_mul_f32 v27, v27, v26
  v_accvgpr_write_b32 a68, v27
  v_accvgpr_read_b32 v28, a69
  v_mul_f32 v28, v28, v26
  v_accvgpr_write_b32 a69, v28
  v_accvgpr_read_b32 v29, a70
  v_mul_f32 v29, v29, v26
  v_accvgpr_write_b32 a70, v29
  v_accvgpr_read_b32 v30, a71
  v_mul_f32 v30, v30, v26
  v_accvgpr_write_b32 a71, v30
  v_accvgpr_read_b32 v27, a72
  v_mul_f32 v27, v27, v26
  v_accvgpr_write_b32 a72, v27
  v_accvgpr_read_b32 v28, a73
  v_mul_f32 v28, v28, v26
  v_accvgpr_write_b32 a73, v28
  v_accvgpr_read_b32 v29, a74
  v_mul_f32 v29, v29, v26
  v_accvgpr_write_b32 a74, v29
  v_accvgpr_read_b32 v30, a75
  v_mul_f32 v30, v30, v26
  v_accvgpr_write_b32 a75, v30
  v_accvgpr_read_b32 v27, a76
  v_mul_f32 v27, v27, v26
  v_accvgpr_write_b32 a76, v27
  v_accvgpr_read_b32 v28, a77
  v_mul_f32 v28, v28, v26
  v_accvgpr_write_b32 a77, v28
  v_accvgpr_read_b32 v29, a78
  v_mul_f32 v29, v29, v26
  v_accvgpr_write_b32 a78, v29
  v_accvgpr_read_b32 v30, a79
  v_mul_f32 v30, v30, v26
  v_accvgpr_write_b32 a79, v30
  v_accvgpr_read_b32 v27, a80
  v_mul_f32 v27, v27, v26
  v_accvgpr_write_b32 a80, v27
  v_accvgpr_read_b32 v28, a81
  v_mul_f32 v28, v28, v26
  v_accvgpr_write_b32 a81, v28
  v_accvgpr_read_b32 v29, a82
  v_mul_f32 v29, v29, v26
  v_accvgpr_write_b32 a82, v29
  v_accvgpr_read_b32 v30, a83
  v_mul_f32 v30, v30, v26
  v_accvgpr_write_b32 a83, v30
  v_accvgpr_read_b32 v27, a84
  v_mul_f32 v27, v27, v26
  v_accvgpr_write_b32 a84, v27
  v_accvgpr_read_b32 v28, a85
  v_mul_f32 v28, v28, v26
  v_accvgpr_write_b32 a85, v28
  v_accvgpr_read_b32 v29, a86
  v_mul_f32 v29, v29, v26
  v_accvgpr_write_b32 a86, v29
  v_accvgpr_read_b32 v30, a87
  v_mul_f32 v30, v30, v26
  v_accvgpr_write_b32 a87, v30
  v_accvgpr_read_b32 v27, a88
  v_mul_f32 v27, v27, v26
  v_accvgpr_write_b32 a88, v27
  v_accvgpr_read_b32 v28, a89
  v_mul_f32 v28, v28, v26
  v_accvgpr_write_b32 a89, v28
  v_accvgpr_read_b32 v29, a90
  v_mul_f32 v29, v29, v26
  v_accvgpr_write_b32 a90, v29
  v_accvgpr_read_b32 v30, a91
  v_mul_f32 v30, v30, v26
  v_accvgpr_write_b32 a91, v30
  v_accvgpr_read_b32 v27, a92
  v_mul_f32 v27, v27, v26
  v_accvgpr_write_b32 a92, v27
  v_accvgpr_read_b32 v28, a93
  v_mul_f32 v28, v28, v26
  v_accvgpr_write_b32 a93, v28
  v_accvgpr_read_b32 v29, a94
  v_mul_f32 v29, v29, v26
  v_accvgpr_write_b32 a94, v29
  v_accvgpr_read_b32 v30, a95
  v_mul_f32 v30, v30, v26
  v_accvgpr_write_b32 a95, v30
  v_accvgpr_read_b32 v27, a96
  v_mul_f32 v27, v27, v26
  v_accvgpr_write_b32 a96, v27
  v_accvgpr_read_b32 v28, a97
  v_mul_f32 v28, v28, v26
  v_accvgpr_write_b32 a97, v28
  v_accvgpr_read_b32 v29, a98
  v_mul_f32 v29, v29, v26
  v_accvgpr_write_b32 a98, v29
  v_accvgpr_read_b32 v30, a99
  v_mul_f32 v30, v30, v26
  v_accvgpr_write_b32 a99, v30
  v_accvgpr_read_b32 v27, a100
  v_mul_f32 v27, v27, v26
  v_accvgpr_write_b32 a100, v27
  v_accvgpr_read_b32 v28, a101
  v_mul_f32 v28, v28, v26
  v_accvgpr_write_b32 a101, v28
  v_accvgpr_read_b32 v29, a102
  v_mul_f32 v29, v29, v26
  v_accvgpr_write_b32 a102, v29
  v_accvgpr_read_b32 v30, a103
  v_mul_f32 v30, v30, v26
  v_accvgpr_write_b32 a103, v30
  v_accvgpr_read_b32 v27, a104
  v_mul_f32 v27, v27, v26
  v_accvgpr_write_b32 a104, v27
  v_accvgpr_read_b32 v28, a105
  v_mul_f32 v28, v28, v26
  v_accvgpr_write_b32 a105, v28
  v_accvgpr_read_b32 v29, a106
  v_mul_f32 v29, v29, v26
  v_accvgpr_write_b32 a106, v29
  v_accvgpr_read_b32 v30, a107
  v_mul_f32 v30, v30, v26
  v_accvgpr_write_b32 a107, v30
  v_accvgpr_read_b32 v27, a108
  v_mul_f32 v27, v27, v26
  v_accvgpr_write_b32 a108, v27
  v_accvgpr_read_b32 v28, a109
  v_mul_f32 v28, v28, v26
  v_accvgpr_write_b32 a109, v28
  v_accvgpr_read_b32 v29, a110
  v_mul_f32 v29, v29, v26
  v_accvgpr_write_b32 a110, v29
  v_accvgpr_read_b32 v30, a111
  v_mul_f32 v30, v30, v26
  v_accvgpr_write_b32 a111, v30
  v_accvgpr_read_b32 v27, a112
  v_mul_f32 v27, v27, v26
  v_accvgpr_write_b32 a112, v27
  v_accvgpr_read_b32 v28, a113
  v_mul_f32 v28, v28, v26
  v_accvgpr_write_b32 a113, v28
  v_accvgpr_read_b32 v29, a114
  v_mul_f32 v29, v29, v26
  v_accvgpr_write_b32 a114, v29
  v_accvgpr_read_b32 v30, a115
  v_mul_f32 v30, v30, v26
  v_accvgpr_write_b32 a115, v30
  v_accvgpr_read_b32 v27, a116
  v_mul_f32 v27, v27, v26
  v_accvgpr_write_b32 a116, v27
  v_accvgpr_read_b32 v28, a117
  v_mul_f32 v28, v28, v26
  v_accvgpr_write_b32 a117, v28
  v_accvgpr_read_b32 v29, a118
  v_mul_f32 v29, v29, v26
  v_accvgpr_write_b32 a118, v29
  v_accvgpr_read_b32 v30, a119
  v_mul_f32 v30, v30, v26
  v_accvgpr_write_b32 a119, v30
  v_accvgpr_read_b32 v27, a120
  v_mul_f32 v27, v27, v26
  v_accvgpr_write_b32 a120, v27
  v_accvgpr_read_b32 v28, a121
  v_mul_f32 v28, v28, v26
  v_accvgpr_write_b32 a121, v28
  v_accvgpr_read_b32 v29, a122
  v_mul_f32 v29, v29, v26
  v_accvgpr_write_b32 a122, v29
  v_accvgpr_read_b32 v30, a123
  v_mul_f32 v30, v30, v26
  v_accvgpr_write_b32 a123, v30
  v_accvgpr_read_b32 v27, a124
  v_mul_f32 v27, v27, v26
  v_accvgpr_write_b32 a124, v27
  v_accvgpr_read_b32 v28, a125
  v_mul_f32 v28, v28, v26
  v_accvgpr_write_b32 a125, v28
  v_accvgpr_read_b32 v29, a126
  v_mul_f32 v29, v29, v26
  v_accvgpr_write_b32 a126, v29
  v_accvgpr_read_b32 v30, a127
  v_mul_f32 v30, v30, v26
  v_accvgpr_write_b32 a127, v30
slowx_p1:
  s_mov_b32 s33, 0x41000000
  s_mov_b32 s36, 0
  s_nop 1
  s_branch back_p1
slow_a:
  v_mov_b32 v25, v22
  s_nop 1
  v_permlane32_swap_b32 v25, v22
  s_nop 1
  v_max_f32 v25, v25, v22
  v_max_f32 v25, s37, v25
  v_sub_f32 v240, v240, v25
  v_sub_f32 v241, v241, v25
  v_sub_f32 v242, v242, v25
  v_sub_f32 v243, v243, v25
  v_sub_f32 v244, v244, v25
  v_sub_f32 v245, v245, v25
  v_sub_f32 v246, v246, v25
  v_sub_f32 v247, v247, v25
  v_sub_f32 v248, v248, v25
  v_sub_f32 v249, v249, v25
  v_sub_f32 v250, v250, v25
  v_sub_f32 v251, v251, v25
  v_sub_f32 v252, v252, v25
  v_sub_f32 v253, v253, v25
  v_sub_f32 v254, v254, v25
  v_sub_f32 v255, v255, v25
  v_sub_f32 v192, v192, v25
  v_sub_f32 v193, v193, v25
  v_sub_f32 v194, v194, v25
  v_sub_f32 v195, v195, v25
  v_sub_f32 v196, v196, v25
  v_sub_f32 v197, v197, v25
  v_sub_f32 v198, v198, v25
  v_sub_f32 v199, v199, v25
  v_sub_f32 v200, v200, v25
  v_sub_f32 v201, v201, v25
  v_sub_f32 v202, v202, v25
  v_sub_f32 v203, v203, v25
  v_sub_f32 v204, v204, v25
  v_sub_f32 v205, v205, v25
  v_sub_f32 v206, v206, v25
  v_sub_f32 v207, v207, v25
  s_cmp_lg_u32 s37, 0
  s_cbranch_scc1 slowx_a
  v_sub_f32 v26, 0, v25
  v_exp_f32 v26, v26
  s_nop 7
  s_nop 7
  v_mul_f32 v36, v36, v26
  v_mul_f32 v37, v37, v26
  v_accvgpr_read_b32 v27, a128
  v_mul_f32 v27, v27, v26
  v_accvgpr_write_b32 a128, v27
  v_accvgpr_read_b32 v28, a129
  v_mul_f32 v28, v28, v26
  v_accvgpr_write_b32 a129, v28
  v_accvgpr_read_b32 v29, a130
  v_mul_f32 v29, v29, v26
  v_accvgpr_write_b32 a130, v29
  v_accvgpr_read_b32 v30, a131
  v_mul_f32 v30, v30, v26
  v_accvgpr_write_b32 a131, v30
  v_accvgpr_read_b32 v27, a132
  v_mul_f32 v27, v27, v26
  v_accvgpr_write_b32 a132, v27
  v_accvgpr_read_b32 v28, a133
  v_mul_f32 v28, v28, v26
  v_accvgpr_write_b32 a133, v28
  v_accvgpr_read_b32 v29, a134
  v_mul_f32 v29, v29, v26
  v_accvgpr_write_b32 a134, v29
  v_accvgpr_read_b32 v30, a135
  v_mul_f32 v30, v30, v26
  v_accvgpr_write_b32 a135, v30
  v_accvgpr_read_b32 v27, a136
  v_mul_f32 v27, v27, v26
  v_accvgpr_write_b32 a136, v27
  v_accvgpr_read_b32 v28, a137
  v_mul_f32 v28, v28, v26
  v_accvgpr_write_b32 a137, v28
  v_accvgpr_read_b32 v29, a138
  v_mul_f32 v29, v29, v26
  v_accvgpr_write_b32 a138, v29
  v_accvgpr_read_b32 v30, a139
  v_mul_f32 v30, v30, v26
  v_accvgpr_write_b32 a139, v30
  v_accvgpr_read_b32 v27, a140
  v_mul_f32 v27, v27, v26
  v_accvgpr_write_b32 a140, v27
  v_accvgpr_read_b32 v28, a141
  v_mul_f32 v28, v28, v26
  v_accvgpr_write_b32 a141, v28
  v_accvgpr_read_b32 v29, a142
  v_mul_f32 v29, v29, v26
  v_accvgpr_write_b32 a142, v29
  v_accvgpr_read_b32 v30, a143
  v_mul_f32 v30, v30, v26
  v_accvgpr_write_b32 a143, v30
  v_accvgpr_read_b32 v27, a144
  v_mul_f32 v27, v27, v26
  v_accvgpr_write_b32 a144, v27
  v_accvgpr_read_b32 v28, a145
  v_mul_f32 v28, v28, v26
  v_accvgpr_write_b32 a145, v28
  v_accvgpr_read_b32 v29, a146
  v_mul_f32 v29, v29, v26
  v_accvgpr_write_b32 a146, v29
  v_accvgpr_read_b32 v30, a147
  v_mul_f32 v30, v30, v26
  v_accvgpr_write_b32 a147, v30
  v_accvgpr_read_b32 v27, a148
  v_mul_f32 v27, v27, v26
  v_accvgpr_write_b32 a148, v27
  v_accvgpr_read_b32 v28, a149
  v_mul_f32 v28, v28, v26
  v_accvgpr_write_b32 a149, v28
  v_accvgpr_read_b32 v29, a150
  v_mul_f32 v29, v29, v26
  v_accvgpr_write_b32 a150, v29
  v_accvgpr_read_b32 v30, a151
  v_mul_f32 v30, v30, v26
  v_accvgpr_write_b32 a151, v30
  v_accvgpr_read_b32 v27, a152
  v_mul_f32 v27, v27, v26
  v_accvgpr_write_b32 a152, v27
  v_accvgpr_read_b32 v28, a153
  v_mul_f32 v28, v28, v26
  v_accvgpr_write_b32 a153, v28
  v_accvgpr_read_b32 v29, a154
  v_mul_f32 v29, v29, v26
  v_accvgpr_write_b32 a154, v29
  v_accvgpr_read_b32 v30, a155
  v_mul_f32 v30, v30, v26
  v_accvgpr_write_b32 a155, v30
  v_accvgpr_read_b32 v27, a156
  v_mul_f32 v27, v27, v26
  v_accvgpr_write_b32 a156, v27
  v_accvgpr_read_b32 v28, a157
  v_mul_f32 v28, v28, v26
  v_accvgpr_write_b32 a157, v28
  v_accvgpr_read_b32 v29, a158
  v_mul_f32 v29, v29, v26
  v_accvgpr_write_b32 a158, v29
  v_accvgpr_read_b32 v30, a159
  v_mul_f32 v30, v30, v26
  v_accvgpr_write_b32 a159, v30
  v_accvgpr_read_b32 v27, a160
  v_mul_f32 v27, v27, v26
  v_accvgpr_write_b32 a160, v27
  v_accvgpr_read_b32 v28, a161
  v_mul_f32 v28, v28, v26
  v_accvgpr_write_b32 a161, v28
  v_accvgpr_read_b32 v29, a162
  v_mul_f32 v29, v29, v26
  v_accvgpr_write_b32 a162, v29
  v_accvgpr_read_b32 v30, a163
  v_mul_f32 v30, v30, v26
  v_accvgpr_write_b32 a163, v30
  v_accvgpr_read_b32 v27, a164
  v_mul_f32 v27, v27, v26
  v_accvgpr_write_b32 a164, v27
  v_accvgpr_read_b32 v28, a165
  v_mul_f32 v28, v28, v26
  v_accvgpr_write_b32 a165, v28
  v_accvgpr_read_b32 v29, a166
  v_mul_f32 v29, v29, v26
  v_accvgpr_write_b32 a166, v29
  v_accvgpr_read_b32 v30, a167
  v_mul_f32 v30, v30, v26
  v_accvgpr_write_b32 a167, v30
  v_accvgpr_read_b32 v27, a168
  v_mul_f32 v27, v27, v26
  v_accvgpr_write_b32 a168, v27
  v_accvgpr_read_b32 v28, a169
  v_mul_f32 v28, v28, v26
  v_accvgpr_write_b32 a169, v28
  v_accvgpr_read_b32 v29, a170
  v_mul_f32 v29, v29, v26
  v_accvgpr_write_b32 a170, v29
  v_accvgpr_read_b32 v30, a171
  v_mul_f32 v30, v30, v26
  v_accvgpr_write_b32 a171, v30
  v_accvgpr_read_b32 v27, a172
  v_mul_f32 v27, v27, v26
  v_accvgpr_write_b32 a172, v27
  v_accvgpr_read_b32 v28, a173
  v_mul_f32 v28, v28, v26
  v_accvgpr_write_b32 a173, v28
  v_accvgpr_read_b32 v29, a174
  v_mul_f32 v29, v29, v26
  v_accvgpr_write_b32 a174, v29
  v_accvgpr_read_b32 v30, a175
  v_mul_f32 v30, v30, v26
  v_accvgpr_write_b32 a175, v30
  v_accvgpr_read_b32 v27, a176
  v_mul_f32 v27, v27, v26
  v_accvgpr_write_b32 a176, v27
  v_accvgpr_read_b32 v28, a177
  v_mul_f32 v28, v28, v26
  v_accvgpr_write_b32 a177, v28
  v_accvgpr_read_b32 v29, a178
  v_mul_f32 v29, v29, v26
  v_accvgpr_write_b32 a178, v29
  v_accvgpr_read_b32 v30, a179
  v_mul_f32 v30, v30, v26
  v_accvgpr_write_b32 a179, v30
  v_accvgpr_read_b32 v27, a180
  v_mul_f32 v27, v27, v26
  v_accvgpr_write_b32 a180, v27
  v_accvgpr_read_b32 v28, a181
  v_mul_f32 v28, v28, v26
  v_accvgpr_write_b32 a181, v28
  v_accvgpr_read_b32 v29, a182
  v_mul_f32 v29, v29, v26
  v_accvgpr_write_b32 a182, v29
  v_accvgpr_read_b32 v30, a183
  v_mul_f32 v30, v30, v26
  v_accvgpr_write_b32 a183, v30
  v_accvgpr_read_b32 v27, a184
  v_mul_f32 v27, v27, v26
  v_accvgpr_write_b32 a184, v27
  v_accvgpr_read_b32 v28, a185
  v_mul_f32 v28, v28, v26
  v_accvgpr_write_b32 a185, v28
  v_accvgpr_read_b32 v29, a186
  v_mul_f32 v29, v29, v26
  v_accvgpr_write_b32 a186, v29
  v_accvgpr_read_b32 v30, a187
  v_mul_f32 v30, v30, v26
  v_accvgpr_write_b32 a187, v30
  v_accvgpr_read_b32 v27, a188
  v_mul_f32 v27, v27, v26
  v_accvgpr_write_b32 a188, v27
  v_accvgpr_read_b32 v28, a189
  v_mul_f32 v28, v28, v26
  v_accvgpr_write_b32 a189, v28
  v_accvgpr_read_b32 v29, a190
  v_mul_f32 v29, v29, v26
  v_accvgpr_write_b32 a190, v29
  v_accvgpr_read_b32 v30, a191
  v_mul_f32 v30, v30, v26
  v_accvgpr_write_b32 a191, v30
slowx_a:
  s_mov_b32 s34, 0x41000000
  s_mov_b32 s37, 0
  s_nop 1
  s_branch back_a
slow_b:
  v_mov_b32 v25, v22
  s_nop 1
  v_permlane32_swap_b32 v25, v22
  s_nop 1
  v_max_f32 v25, v25, v22
  v_max_f32 v25, s35, v25
  v_sub_f32 v208, v208, v25
  v_sub_f32 v209, v209, v25
  v_sub_f32 v210, v210, v25
  v_sub_f32 v211, v211, v25
  v_sub_f32 v212, v212, v25
  v_sub_f32 v213, v213, v25
  v_sub_f32 v214, v214, v25
  v_sub_f32 v215, v215, v25
  v_sub_f32 v216, v216, v25
  v_sub_f32 v217, v217, v25
  v_sub_f32 v218, v218, v25
  v_sub_f32 v219, v219, v25
  v_sub_f32 v220, v220, v25
  v_sub_f32 v221, v221, v25
  v_sub_f32 v222, v222, v25
  v_sub_f32 v223, v223, v25
  v_sub_f32 v160, v160, v25
  v_sub_f32 v161, v161, v25
  v_sub_f32 v162, v162, v25
  v_sub_f32 v163, v163, v25
  v_sub_f32 v164, v164, v25
  v_sub_f32 v165, v165, v25
  v_sub_f32 v166, v166, v25
  v_sub_f32 v167, v167, v25
  v_sub_f32 v168, v168, v25
  v_sub_f32 v169, v169, v25
  v_sub_f32 v170, v170, v25
  v_sub_f32 v171, v171, v25
  v_sub_f32 v172, v172, v25
  v_sub_f32 v173, v173, v25
  v_sub_f32 v174, v174, v25
  v_sub_f32 v175, v175, v25
  s_cmp_lg_u32 s35, 0
  s_cbranch_scc1 slowx_b
  v_sub_f32 v26, 0, v25
  v_exp_f32 v26, v26
  s_nop 7
  s_nop 7
  v_mul_f32 v32, v32, v26
  v_mul_f32 v33, v33, v26
  v_accvgpr_read_b32 v27, a0
  v_mul_f32 v27, v27, v26
  v_accvgpr_write_b32 a0, v27
  v_accvgpr_read_b32 v28, a1
  v_mul_f32 v28, v28, v26
  v_accvgpr_write_b32 a1, v28
  v_accvgpr_read_b32 v29, a2
  v_mul_f32 v29, v29, v26
  v_accvgpr_write_b32 a2, v29
  v_accvgpr_read_b32 v30, a3
  v_mul_f32 v30, v30, v26
  v_accvgpr_write_b32 a3, v30
  v_accvgpr_read_b32 v27, a4
  v_mul_f32 v27, v27, v26
  v_accvgpr_write_b32 a4, v27
  v_accvgpr_read_b32 v28, a5
  v_mul_f32 v28, v28, v26
  v_accvgpr_write_b32 a5, v28
  v_accvgpr_read_b32 v29, a6
  v_mul_f32 v29, v29, v26
  v_accvgpr_write_b32 a6, v29
  v_accvgpr_read_b32 v30, a7
  v_mul_f32 v30, v30, v26
  v_accvgpr_write_b32 a7, v30
  v_accvgpr_read_b32 v27, a8
  v_mul_f32 v27, v27, v26
  v_accvgpr_write_b32 a8, v27
  v_accvgpr_read_b32 v28, a9
  v_mul_f32 v28, v28, v26
  v_accvgpr_write_b32 a9, v28
  v_accvgpr_read_b32 v29, a10
  v_mul_f32 v29, v29, v26
  v_accvgpr_write_b32 a10, v29
  v_accvgpr_read_b32 v30, a11
  v_mul_f32 v30, v30, v26
  v_accvgpr_write_b32 a11, v30
  v_accvgpr_read_b32 v27, a12
  v_mul_f32 v27, v27, v26
  v_accvgpr_write_b32 a12, v27
  v_accvgpr_read_b32 v28, a13
  v_mul_f32 v28, v28, v26
  v_accvgpr_write_b32 a13, v28
  v_accvgpr_read_b32 v29, a14
  v_mul_f32 v29, v29, v26
  v_accvgpr_write_b32 a14, v29
  v_accvgpr_read_b32 v30, a15
  v_mul_f32 v30, v30, v26
  v_accvgpr_write_b32 a15, v30
  v_accvgpr_read_b32 v27, a16
  v_mul_f32 v27, v27, v26
  v_accvgpr_write_b32 a16, v27
  v_accvgpr_read_b32 v28, a17
  v_mul_f32 v28, v28, v26
  v_accvgpr_write_b32 a17, v28
  v_accvgpr_read_b32 v29, a18
  v_mul_f32 v29, v29, v26
  v_accvgpr_write_b32 a18, v29
  v_accvgpr_read_b32 v30, a19
  v_mul_f32 v30, v30, v26
  v_accvgpr_write_b32 a19, v30
  v_accvgpr_read_b32 v27, a20
  v_mul_f32 v27, v27, v26
  v_accvgpr_write_b32 a20, v27
  v_accvgpr_read_b32 v28, a21
  v_mul_f32 v28, v28, v26
  v_accvgpr_write_b32 a21, v28
  v_accvgpr_read_b32 v29, a22
  v_mul_f32 v29, v29, v26
  v_accvgpr_write_b32 a22, v29
  v_accvgpr_read_b32 v30, a23
  v_mul_f32 v30, v30, v26
  v_accvgpr_write_b32 a23, v30
  v_accvgpr_read_b32 v27, a24
  v_mul_f32 v27, v27, v26
  v_accvgpr_write_b32 a24, v27
  v_accvgpr_read_b32 v28, a25
  v_mul_f32 v28, v28, v26
  v_accvgpr_write_b32 a25, v28
  v_accvgpr_read_b32 v29, a26
  v_mul_f32 v29, v29, v26
  v_accvgpr_write_b32 a26, v29
  v_accvgpr_read_b32 v30, a27
  v_mul_f32 v30, v30, v26
  v_accvgpr_write_b32 a27, v30
  v_accvgpr_read_b32 v27, a28
  v_mul_f32 v27, v27, v26
  v_accvgpr_write_b32 a28, v27
  v_accvgpr_read_b32 v28, a29
  v_mul_f32 v28, v28, v26
  v_accvgpr_write_b32 a29, v28
  v_accvgpr_read_b32 v29, a30
  v_mul_f32 v29, v29, v26
  v_accvgpr_write_b32 a30, v29
  v_accvgpr_read_b32 v30, a31
  v_mul_f32 v30, v30, v26
  v_accvgpr_write_b32 a31, v30
  v_accvgpr_read_b32 v27, a32
  v_mul_f32 v27, v27, v26
  v_accvgpr_write_b32 a32, v27
  v_accvgpr_read_b32 v28, a33
  v_mul_f32 v28, v28, v26
  v_accvgpr_write_b32 a33, v28
  v_accvgpr_read_b32 v29, a34
  v_mul_f32 v29, v29, v26
  v_accvgpr_write_b32 a34, v29
  v_accvgpr_read_b32 v30, a35
  v_mul_f32 v30, v30, v26
  v_accvgpr_write_b32 a35, v30
  v_accvgpr_read_b32 v27, a36
  v_mul_f32 v27, v27, v26
  v_accvgpr_write_b32 a36, v27
  v_accvgpr_read_b32 v28, a37
  v_mul_f32 v28, v28, v26
  v_accvgpr_write_b32 a37, v28
  v_accvgpr_read_b32 v29, a38
  v_mul_f32 v29, v29, v26
  v_accvgpr_write_b32 a38, v29
  v_accvgpr_read_b32 v30, a39
  v_mul_f32 v30, v30, v26
  v_accvgpr_write_b32 a39, v30
  v_accvgpr_read_b32 v27, a40
  v_mul_f32 v27, v27, v26
  v_accvgpr_write_b32 a40, v27
  v_accvgpr_read_b32 v28, a41
  v_mul_f32 v28, v28, v26
  v_accvgpr_write_b32 a41, v28
  v_accvgpr_read_b32 v29, a42
  v_mul_f32 v29, v29, v26
  v_accvgpr_write_b32 a42, v29
  v_accvgpr_read_b32 v30, a43
  v_mul_f32 v30, v30, v26
  v_accvgpr_write_b32 a43, v30
  v_accvgpr_read_b32 v27, a44
  v_mul_f32 v27, v27, v26
  v_accvgpr_write_b32 a44, v27
  v_accvgpr_read_b32 v28, a45
  v_mul_f32 v28, v28, v26
  v_accvgpr_write_b32 a45, v28
  v_accvgpr_read_b32 v29, a46
  v_mul_f32 v29, v29, v26
  v_accvgpr_write_b32 a46, v29
  v_accvgpr_read_b32 v30, a47
  v_mul_f32 v30, v30, v26
  v_accvgpr_write_b32 a47, v30
  v_accvgpr_read_b32 v27, a48
  v_mul_f32 v27, v27, v26
  v_accvgpr_write_b32 a48, v27
  v_accvgpr_read_b32 v28, a49
  v_mul_f32 v28, v28, v26
  v_accvgpr_write_b32 a49, v28
  v_accvgpr_read_b32 v29, a50
  v_mul_f32 v29, v29, v26
  v_accvgpr_write_b32 a50, v29
  v_accvgpr_read_b32 v30, a51
  v_mul_f32 v30, v30, v26
  v_accvgpr_write_b32 a51, v30
  v_accvgpr_read_b32 v27, a52
  v_mul_f32 v27, v27, v26
  v_accvgpr_write_b32 a52, v27
  v_accvgpr_read_b32 v28, a53
  v_mul_f32 v28, v28, v26
  v_accvgpr_write_b32 a53, v28
  v_accvgpr_read_b32 v29, a54
  v_mul_f32 v29, v29, v26
  v_accvgpr_write_b32 a54, v29
  v_accvgpr_read_b32 v30, a55
  v_mul_f32 v30, v30, v26
  v_accvgpr_write_b32 a55, v30
  v_accvgpr_read_b32 v27, a56
  v_mul_f32 v27, v27, v26
  v_accvgpr_write_b32 a56, v27
  v_accvgpr_read_b32 v28, a57
  v_mul_f32 v28, v28, v26
  v_accvgpr_write_b32 a57, v28
  v_accvgpr_read_b32 v29, a58
  v_mul_f32 v29, v29, v26
  v_accvgpr_write_b32 a58, v29
  v_accvgpr_read_b32 v30, a59
  v_mul_f32 v30, v30, v26
  v_accvgpr_write_b32 a59, v30
  v_accvgpr_read_b32 v27, a60
  v_mul_f32 v27, v27, v26
  v_accvgpr_write_b32 a60, v27
  v_accvgpr_read_b32 v28, a61
  v_mul_f32 v28, v28, v26
  v_accvgpr_write_b32 a61, v28
  v_accvgpr_read_b32 v29, a62
  v_mul_f32 v29, v29, v26
  v_accvgpr_write_b32 a62, v29
  v_accvgpr_read_b32 v30, a63
  v_mul_f32 v30, v30, v26
  v_accvgpr_write_b32 a63, v30
slowx_b:
  s_mov_b32 s32, 0x41000000
  s_mov_b32 s35, 0
  s_nop 1
  s_branch back_b
slow_c:
  v_mov_b32 v25, v22
  s_nop 1
  v_permlane32_swap_b32 v25, v22
  s_nop 1
  v_max_f32 v25, v25, v22
  v_max_f32 v25, s36, v25
  v_sub_f32 v224, v224, v25
  v_sub_f32 v225, v225, v25
  v_sub_f32 v226, v226, v25
  v_sub_f32 v227, v227, v25
  v_sub_f32 v228, v228, v25
  v_sub_f32 v229, v229, v25
  v_sub_f32 v230, v230, v25
  v_sub_f32 v231, v231, v25
  v_sub_f32 v232, v232, v25
  v_sub_f32 v233, v233, v25
  v_sub_f32 v234, v234, v25
  v_sub_f32 v235, v235, v25
  v_sub_f32 v236, v236, v25
  v_sub_f32 v237, v237, v25
  v_sub_f32 v238, v238, v25
  v_sub_f32 v239, v239, v25
  v_sub_f32 v176, v176, v25
  v_sub_f32 v177, v177, v25
  v_sub_f32 v178, v178, v25
  v_sub_f32 v179, v179, v25
  v_sub_f32 v180, v180, v25
  v_sub_f32 v181, v181, v25
  v_sub_f32 v182, v182, v25
  v_sub_f32 v183, v183, v25
  v_sub_f32 v184, v184, v25
  v_sub_f32 v185, v185, v25
  v_sub_f32 v186, v186, v25
  v_sub_f32 v187, v187, v25
  v_sub_f32 v188, v188, v25
  v_sub_f32 v189, v189, v25
  v_sub_f32 v190, v190, v25
  v_sub_f32 v191, v191, v25
  s_cmp_lg_u32 s36, 0
  s_cbranch_scc1 slowx_c
  v_sub_f32 v26, 0, v25
  v_exp_f32 v26, v26
  s_nop 7
  s_nop 7
  v_mul_f32 v34, v34, v26
  v_mul_f32 v35, v35, v26
  v_accvgpr_read_b32 v27, a64
  v_mul_f32 v27, v27, v26
  v_accvgpr_write_b32 a64, v27
  v_accvgpr_read_b32 v28, a65
  v_mul_f32 v28, v28, v26
  v_accvgpr_write_b32 a65, v28
  v_accvgpr_read_b32 v29, a66
  v_mul_f32 v29, v29, v26
  v_accvgpr_write_b32 a66, v29
  v_accvgpr_read_b32 v30, a67
  v_mul_f32 v30, v30, v26
  v_accvgpr_write_b32 a67, v30
  v_accvgpr_read_b32 v27, a68
  v_mul_f32 v27, v27, v26
  v_accvgpr_write_b32 a68, v27
  v_accvgpr_read_b32 v28, a69
  v_mul_f32 v28, v28, v26
  v_accvgpr_write_b32 a69, v28
  v_accvgpr_read_b32 v29, a70
  v_mul_f32 v29, v29, v26
  v_accvgpr_write_b32 a70, v29
  v_accvgpr_read_b32 v30, a71
  v_mul_f32 v30, v30, v26
  v_accvgpr_write_b32 a71, v30
  v_accvgpr_read_b32 v27, a72
  v_mul_f32 v27, v27, v26
  v_accvgpr_write_b32 a72, v27
  v_accvgpr_read_b32 v28, a73
  v_mul_f32 v28, v28, v26
  v_accvgpr_write_b32 a73, v28
  v_accvgpr_read_b32 v29, a74
  v_mul_f32 v29, v29, v26
  v_accvgpr_write_b32 a74, v29
  v_accvgpr_read_b32 v30, a75
  v_mul_f32 v30, v30, v26
  v_accvgpr_write_b32 a75, v30
  v_accvgpr_read_b32 v27, a76
  v_mul_f32 v27, v27, v26
  v_accvgpr_write_b32 a76, v27
  v_accvgpr_read_b32 v28, a77
  v_mul_f32 v28, v28, v26
  v_accvgpr_write_b32 a77, v28
  v_accvgpr_read_b32 v29, a78
  v_mul_f32 v29, v29, v26
  v_accvgpr_write_b32 a78, v29
  v_accvgpr_read_b32 v30, a79
  v_mul_f32 v30, v30, v26
  v_accvgpr_write_b32 a79, v30
  v_accvgpr_read_b32 v27, a80
  v_mul_f32 v27, v27, v26
  v_accvgpr_write_b32 a80, v27
  v_accvgpr_read_b32 v28, a81
  v_mul_f32 v28, v28, v26
  v_accvgpr_write_b32 a81, v28
  v_accvgpr_read_b32 v29, a82
  v_mul_f32 v29, v29, v26
  v_accvgpr_write_b32 a82, v29
  v_accvgpr_read_b32 v30, a83
  v_mul_f32 v30, v30, v26
  v_accvgpr_write_b32 a83, v30
  v_accvgpr_read_b32 v27, a84
  v_mul_f32 v27, v27, v26
  v_accvgpr_write_b32 a84, v27
  v_accvgpr_read_b32 v28, a85
  v_mul_f32 v28, v28, v26
  v_accvgpr_write_b32 a85, v28
  v_accvgpr_read_b32 v29, a86
  v_mul_f32 v29, v29, v26
  v_accvgpr_write_b32 a86, v29
  v_accvgpr_read_b32 v30, a87
  v_mul_f32 v30, v30, v26
  v_accvgpr_write_b32 a87, v30
  v_accvgpr_read_b32 v27, a88
  v_mul_f32 v27, v27, v26
  v_accvgpr_write_b32 a88, v27
  v_accvgpr_read_b32 v28, a89
  v_mul_f32 v28, v28, v26
  v_accvgpr_write_b32 a89, v28
  v_accvgpr_read_b32 v29, a90
  v_mul_f32 v29, v29, v26
  v_accvgpr_write_b32 a90, v29
  v_accvgpr_read_b32 v30, a91
  v_mul_f32 v30, v30, v26
  v_accvgpr_write_b32 a91, v30
  v_accvgpr_read_b32 v27, a92
  v_mul_f32 v27, v27, v26
  v_accvgpr_write_b32 a92, v27
  v_accvgpr_read_b32 v28, a93
  v_mul_f32 v28, v28, v26
  v_accvgpr_write_b32 a93, v28
  v_accvgpr_read_b32 v29, a94
  v_mul_f32 v29, v29, v26
  v_accvgpr_write_b32 a94, v29
  v_accvgpr_read_b32 v30, a95
  v_mul_f32 v30, v30, v26
  v_accvgpr_write_b32 a95, v30
  v_accvgpr_read_b32 v27, a96
  v_mul_f32 v27, v27, v26
  v_accvgpr_write_b32 a96, v27
  v_accvgpr_read_b32 v28, a97
  v_mul_f32 v28, v28, v26
  v_accvgpr_write_b32 a97, v28
  v_accvgpr_read_b32 v29, a98
  v_mul_f32 v29, v29, v26
  v_accvgpr_write_b32 a98, v29
  v_accvgpr_read_b32 v30, a99
  v_mul_f32 v30, v30, v26
  v_accvgpr_write_b32 a99, v30
  v_accvgpr_read_b32 v27, a100
  v_mul_f32 v27, v27, v26
  v_accvgpr_write_b32 a100, v27
  v_accvgpr_read_b32 v28, a101
  v_mul_f32 v28, v28, v26
  v_accvgpr_write_b32 a101, v28
  v_accvgpr_read_b32 v29, a102
  v_mul_f32 v29, v29, v26
  v_accvgpr_write_b32 a102, v29
  v_accvgpr_read_b32 v30, a103
  v_mul_f32 v30, v30, v26
  v_accvgpr_write_b32 a103, v30
  v_accvgpr_read_b32 v27, a104
  v_mul_f32 v27, v27, v26
  v_accvgpr_write_b32 a104, v27
  v_accvgpr_read_b32 v28, a105
  v_mul_f32 v28, v28, v26
  v_accvgpr_write_b32 a105, v28
  v_accvgpr_read_b32 v29, a106
  v_mul_f32 v29, v29, v26
  v_accvgpr_write_b32 a106, v29
  v_accvgpr_read_b32 v30, a107
  v_mul_f32 v30, v30, v26
  v_accvgpr_write_b32 a107, v30
  v_accvgpr_read_b32 v27, a108
  v_mul_f32 v27, v27, v26
  v_accvgpr_write_b32 a108, v27
  v_accvgpr_read_b32 v28, a109
  v_mul_f32 v28, v28, v26
  v_accvgpr_write_b32 a109, v28
  v_accvgpr_read_b32 v29, a110
  v_mul_f32 v29, v29, v26
  v_accvgpr_write_b32 a110, v29
  v_accvgpr_read_b32 v30, a111
  v_mul_f32 v30, v30, v26
  v_accvgpr_write_b32 a111, v30
  v_accvgpr_read_b32 v27, a112
  v_mul_f32 v27, v27, v26
  v_accvgpr_write_b32 a112, v27
  v_accvgpr_read_b32 v28, a113
  v_mul_f32 v28, v28, v26
  v_accvgpr_write_b32 a113, v28
  v_accvgpr_read_b32 v29, a114
  v_mul_f32 v29, v29, v26
  v_accvgpr_write_b32 a114, v29
  v_accvgpr_read_b32 v30, a115
  v_mul_f32 v30, v30, v26
  v_accvgpr_write_b32 a115, v30
  v_accvgpr_read_b32 v27, a116
  v_mul_f32 v27, v27, v26
  v_accvgpr_write_b32 a116, v27
  v_accvgpr_read_b32 v28, a117
  v_mul_f32 v28, v28, v26
  v_accvgpr_write_b32 a117, v28
  v_accvgpr_read_b32 v29, a118
  v_mul_f32 v29, v29, v26
  v_accvgpr_write_b32 a118, v29
  v_accvgpr_read_b32 v30, a119
  v_mul_f32 v30, v30, v26
  v_accvgpr_write_b32 a119, v30
  v_accvgpr_read_b32 v27, a120
  v_mul_f32 v27, v27, v26
  v_accvgpr_write_b32 a120, v27
  v_accvgpr_read_b32 v28, a121
  v_mul_f32 v28, v28, v26
  v_accvgpr_write_b32 a121, v28
  v_accvgpr_read_b32 v29, a122
  v_mul_f32 v29, v29, v26
  v_accvgpr_write_b32 a122, v29
  v_accvgpr_read_b32 v30, a123
  v_mul_f32 v30, v30, v26
  v_accvgpr_write_b32 a123, v30
  v_accvgpr_read_b32 v27, a124
  v_mul_f32 v27, v27, v26
  v_accvgpr_write_b32 a124, v27
  v_accvgpr_read_b32 v28, a125
  v_mul_f32 v28, v28, v26
  v_accvgpr_write_b32 a125, v28
  v_accvgpr_read_b32 v29, a126
  v_mul_f32 v29, v29, v26
  v_accvgpr_write_b32 a126, v29
  v_accvgpr_read_b32 v30, a127
  v_mul_f32 v30, v30, v26
  v_accvgpr_write_b32 a127, v30
slowx_c:
  s_mov_b32 s33, 0x41000000
  s_mov_b32 s36, 0
  s_nop 1
  s_branch back_c
slow_e:
  v_mov_b32 v25, v22
  s_nop 1
  v_permlane32_swap_b32 v25, v22
  s_nop 1
  v_max_f32 v25, v25, v22
  v_max_f32 v25, s37, v25
  v_sub_f32 v240, v240, v25
  v_sub_f32 v241, v241, v25
  v_sub_f32 v242, v242, v25
  v_sub_f32 v243, v243, v25
  v_sub_f32 v244, v244, v25
  v_sub_f32 v245, v245, v25
  v_sub_f32 v246, v246, v25
  v_sub_f32 v247, v247, v25
  v_sub_f32 v248, v248, v25
  v_sub_f32 v249, v249, v25
  v_sub_f32 v250, v250, v25
  v_sub_f32 v251, v251, v25
  v_sub_f32 v252, v252, v25
  v_sub_f32 v253, v253, v25
  v_sub_f32 v254, v254, v25
  v_sub_f32 v255, v255, v25
  v_sub_f32 v192, v192, v25
  v_sub_f32 v193, v193, v25
  v_sub_f32 v194, v194, v25
  v_sub_f32 v195, v195, v25
  v_sub_f32 v196, v196, v25
  v_sub_f32 v197, v197, v25
  v_sub_f32 v198, v198, v25
  v_sub_f32 v199, v199, v25
  v_sub_f32 v200, v200, v25
  v_sub_f32 v201, v201, v25
  v_sub_f32 v202, v202, v25
  v_sub_f32 v203, v203, v25
  v_sub_f32 v204, v204, v25
  v_sub_f32 v205, v205, v25
  v_sub_f32 v206, v206, v25
  v_sub_f32 v207, v207, v25
  s_cmp_lg_u32 s37, 0
  s_cbranch_scc1 slowx_e
  v_sub_f32 v26, 0, v25
  v_exp_f32 v26, v26
  s_nop 7
  s_nop 7
  v_mul_f32 v36, v36, v26
  v_mul_f32 v37, v37, v26
  v_accvgpr_read_b32 v27, a128
  v_mul_f32 v27, v27, v26
  v_accvgpr_write_b32 a128, v27
  v_accvgpr_read_b32 v28, a129
  v_mul_f32 v28, v28, v26
  v_accvgpr_write_b32 a129, v28
  v_accvgpr_read_b32 v29, a130
  v_mul_f32 v29, v29, v26
  v_accvgpr_write_b32 a130, v29
  v_accvgpr_read_b32 v30, a131
  v_mul_f32 v30, v30, v26
  v_accvgpr_write_b32 a131, v30
  v_accvgpr_read_b32 v27, a132
  v_mul_f32 v27, v27, v26
  v_accvgpr_write_b32 a132, v27
  v_accvgpr_read_b32 v28, a133
  v_mul_f32 v28, v28, v26
  v_accvgpr_write_b32 a133, v28
  v_accvgpr_read_b32 v29, a134
  v_mul_f32 v29, v29, v26
  v_accvgpr_write_b32 a134, v29
  v_accvgpr_read_b32 v30, a135
  v_mul_f32 v30, v30, v26
  v_accvgpr_write_b32 a135, v30
  v_accvgpr_read_b32 v27, a136
  v_mul_f32 v27, v27, v26
  v_accvgpr_write_b32 a136, v27
  v_accvgpr_read_b32 v28, a137
  v_mul_f32 v28, v28, v26
  v_accvgpr_write_b32 a137, v28
  v_accvgpr_read_b32 v29, a138
  v_mul_f32 v29, v29, v26
  v_accvgpr_write_b32 a138, v29
  v_accvgpr_read_b32 v30, a139
  v_mul_f32 v30, v30, v26
  v_accvgpr_write_b32 a139, v30
  v_accvgpr_read_b32 v27, a140
  v_mul_f32 v27, v27, v26
  v_accvgpr_write_b32 a140, v27
  v_accvgpr_read_b32 v28, a141
  v_mul_f32 v28, v28, v26
  v_accvgpr_write_b32 a141, v28
  v_accvgpr_read_b32 v29, a142
  v_mul_f32 v29, v29, v26
  v_accvgpr_write_b32 a142, v29
  v_accvgpr_read_b32 v30, a143
  v_mul_f32 v30, v30, v26
  v_accvgpr_write_b32 a143, v30
  v_accvgpr_read_b32 v27, a144
  v_mul_f32 v27, v27, v26
  v_accvgpr_write_b32 a144, v27
  v_accvgpr_read_b32 v28, a145
  v_mul_f32 v28, v28, v26
  v_accvgpr_write_b32 a145, v28
  v_accvgpr_read_b32 v29, a146
  v_mul_f32 v29, v29, v26
  v_accvgpr_write_b32 a146, v29
  v_accvgpr_read_b32 v30, a147
  v_mul_f32 v30, v30, v26
  v_accvgpr_write_b32 a147, v30
  v_accvgpr_read_b32 v27, a148
  v_mul_f32 v27, v27, v26
  v_accvgpr_write_b32 a148, v27
  v_accvgpr_read_b32 v28, a149
  v_mul_f32 v28, v28, v26
  v_accvgpr_write_b32 a149, v28
  v_accvgpr_read_b32 v29, a150
  v_mul_f32 v29, v29, v26
  v_accvgpr_write_b32 a150, v29
  v_accvgpr_read_b32 v30, a151
  v_mul_f32 v30, v30, v26
  v_accvgpr_write_b32 a151, v30
  v_accvgpr_read_b32 v27, a152
  v_mul_f32 v27, v27, v26
  v_accvgpr_write_b32 a152, v27
  v_accvgpr_read_b32 v28, a153
  v_mul_f32 v28, v28, v26
  v_accvgpr_write_b32 a153, v28
  v_accvgpr_read_b32 v29, a154
  v_mul_f32 v29, v29, v26
  v_accvgpr_write_b32 a154, v29
  v_accvgpr_read_b32 v30, a155
  v_mul_f32 v30, v30, v26
  v_accvgpr_write_b32 a155, v30
  v_accvgpr_read_b32 v27, a156
  v_mul_f32 v27, v27, v26
  v_accvgpr_write_b32 a156, v27
  v_accvgpr_read_b32 v28, a157
  v_mul_f32 v28, v28, v26
  v_accvgpr_write_b32 a157, v28
  v_accvgpr_read_b32 v29, a158
  v_mul_f32 v29, v29, v26
  v_accvgpr_write_b32 a158, v29
  v_accvgpr_read_b32 v30, a159
  v_mul_f32 v30, v30, v26
  v_accvgpr_write_b32 a159, v30
  v_accvgpr_read_b32 v27, a160
  v_mul_f32 v27, v27, v26
  v_accvgpr_write_b32 a160, v27
  v_accvgpr_read_b32 v28, a161
  v_mul_f32 v28, v28, v26
  v_accvgpr_write_b32 a161, v28
  v_accvgpr_read_b32 v29, a162
  v_mul_f32 v29, v29, v26
  v_accvgpr_write_b32 a162, v29
  v_accvgpr_read_b32 v30, a163
  v_mul_f32 v30, v30, v26
  v_accvgpr_write_b32 a163, v30
  v_accvgpr_read_b32 v27, a164
  v_mul_f32 v27, v27, v26
  v_accvgpr_write_b32 a164, v27
  v_accvgpr_read_b32 v28, a165
  v_mul_f32 v28, v28, v26
  v_accvgpr_write_b32 a165, v28
  v_accvgpr_read_b32 v29, a166
  v_mul_f32 v29, v29, v26
  v_accvgpr_write_b32 a166, v29
  v_accvgpr_read_b32 v30, a167
  v_mul_f32 v30, v30, v26
  v_accvgpr_write_b32 a167, v30
  v_accvgpr_read_b32 v27, a168
  v_mul_f32 v27, v27, v26
  v_accvgpr_write_b32 a168, v27
  v_accvgpr_read_b32 v28, a169
  v_mul_f32 v28, v28, v26
  v_accvgpr_write_b32 a169, v28
  v_accvgpr_read_b32 v29, a170
  v_mul_f32 v29, v29, v26
  v_accvgpr_write_b32 a170, v29
  v_accvgpr_read_b32 v30, a171
  v_mul_f32 v30, v30, v26
  v_accvgpr_write_b32 a171, v30
  v_accvgpr_read_b32 v27, a172
  v_mul_f32 v27, v27, v26
  v_accvgpr_write_b32 a172, v27
  v_accvgpr_read_b32 v28, a173
  v_mul_f32 v28, v28, v26
  v_accvgpr_write_b32 a173, v28
  v_accvgpr_read_b32 v29, a174
  v_mul_f32 v29, v29, v26
  v_accvgpr_write_b32 a174, v29
  v_accvgpr_read_b32 v30, a175
  v_mul_f32 v30, v30, v26
  v_accvgpr_write_b32 a175, v30
  v_accvgpr_read_b32 v27, a176
  v_mul_f32 v27, v27, v26
  v_accvgpr_write_b32 a176, v27
  v_accvgpr_read_b32 v28, a177
  v_mul_f32 v28, v28, v26
  v_accvgpr_write_b32 a177, v28
  v_accvgpr_read_b32 v29, a178
  v_mul_f32 v29, v29, v26
  v_accvgpr_write_b32 a178, v29
  v_accvgpr_read_b32 v30, a179
  v_mul_f32 v30, v30, v26
  v_accvgpr_write_b32 a179, v30
  v_accvgpr_read_b32 v27, a180
  v_mul_f32 v27, v27, v26
  v_accvgpr_write_b32 a180, v27
  v_accvgpr_read_b32 v28, a181
  v_mul_f32 v28, v28, v26
  v_accvgpr_write_b32 a181, v28
  v_accvgpr_read_b32 v29, a182
  v_mul_f32 v29, v29, v26
  v_accvgpr_write_b32 a182, v29
  v_accvgpr_read_b32 v30, a183
  v_mul_f32 v30, v30, v26
  v_accvgpr_write_b32 a183, v30
  v_accvgpr_read_b32 v27, a184
  v_mul_f32 v27, v27, v26
  v_accvgpr_write_b32 a184, v27
  v_accvgpr_read_b32 v28, a185
  v_mul_f32 v28, v28, v26
  v_accvgpr_write_b32 a185, v28
  v_accvgpr_read_b32 v29, a186
  v_mul_f32 v29, v29, v26
  v_accvgpr_write_b32 a186, v29
  v_accvgpr_read_b32 v30, a187
  v_mul_f32 v30, v30, v26
  v_accvgpr_write_b32 a187, v30
  v_accvgpr_read_b32 v27, a188
  v_mul_f32 v27, v27, v26
  v_accvgpr_write_b32 a188, v27
  v_accvgpr_read_b32 v28, a189
  v_mul_f32 v28, v28, v26
  v_accvgpr_write_b32 a189, v28
  v_accvgpr_read_b32 v29, a190
  v_mul_f32 v29, v29, v26
  v_accvgpr_write_b32 a190, v29
  v_accvgpr_read_b32 v30, a191
  v_mul_f32 v30, v30, v26
  v_accvgpr_write_b32 a191, v30
slowx_e:
  s_mov_b32 s34, 0x41000000
  s_mov_b32 s37, 0
  s_nop 1
  s_branch back_e
.globl k2_kernel
.p2align 8
.type k2_kernel,@function
k2_kernel:
  s_cmp_ge_u32 s2, 256
  s_cbranch_scc1 k2_end
  s_load_dwordx2 s[28:29], s[0:1], 32
  s_load_dwordx2 s[30:31], s[0:1], 72
  s_load_dwordx2 s[32:33], s[0:1], 80
  s_load_dwordx2 s[34:35], s[0:1], 96
  v_lshrrev_b32 v1, 6, v0
  v_and_b32 v0, 63, v0
  s_and_b32 s3, s2, 1
  v_readfirstlane_b32 s20, v1
  s_lshr_b32 s4, s2, 3
  s_bfe_u32 s5, s2, 0x20001
  s_lshl_b32 s5, s5, 2
  s_and_b32 s6, s4, 3
  s_add_u32 s5, s5, s6
  s_lshr_b32 s6, s4, 2
  v_lshlrev_b32 v2, 4, v0
  v_add_u32 v3, 0x40000, v2
  v_add_u32 v4, 0x80000, v2
  v_lshrrev_b32 v12, 3, v0
  v_and_b32 v13, 7, v0
  v_bfe_u32 v14, v0, 4, 1
  v_lshlrev_b32 v14, 2, v14
  v_xor_b32 v13, v13, v14
  v_lshlrev_b32 v13, 4, v13
  v_lshl_add_u32 v5, v12, 10, v13
  v_add_u32 v6, 7168, v5
  s_waitcnt lgkmcnt(0)
  s_cmp_eq_u32 s3, 0
  s_cselect_b32 s12, s28, s30
  s_cselect_b32 s13, s29, s31
  s_lshl_b32 s7, s6, 7
  s_add_u32 s12, s12, s7
  s_addc_u32 s13, s13, 0
  s_and_b32 s13, s13, 0xffff
  s_mov_b32 s14, 4194304
  s_mov_b32 s15, 0x20000
  s_mul_i32 s7, s3, 48
  s_mul_i32 s25, s5, 3
  s_add_u32 s7, s7, s25
  s_lshl_b32 s7, s7, 2
  s_add_u32 s7, s7, s20
  s_lshl_b32 s7, s7, 16
  s_add_u32 s8, s34, s7
  s_addc_u32 s9, s35, 0
  s_and_b32 s9, s9, 0xffff
  s_mov_b32 s10, 589824
  s_mov_b32 s11, 0x20000
  s_mov_b32 s21, 0
  s_lshl_b32 s22, s20, 20
  s_lshl_b32 s23, s20, 15
  buffer_load_dwordx4 a[0:3], v2, s[8:11], s21 offen
  buffer_load_dwordx4 a[4:7], v3, s[8:11], s21 offen
  buffer_load_dwordx4 a[8:11], v4, s[8:11], s21 offen
  s_add_u32 m0, s23, 0
  s_add_u32 s21, s21, 1024
  buffer_load_dwordx4 v5, s[12:15], s22 offen lds
  buffer_load_dwordx4 v6, s[12:15], s22 offen offset:1024 lds
  s_add_u32 s22, s22, 16384
  buffer_load_dwordx4 a[12:15], v2, s[8:11], s21 offen
  buffer_load_dwordx4 a[16:19], v3, s[8:11], s21 offen
  buffer_load_dwordx4 a[20:23], v4, s[8:11], s21 offen
  s_add_u32 m0, s23, 2048
  s_add_u32 s21, s21, 1024
  buffer_load_dwordx4 v5, s[12:15], s22 offen lds
  buffer_load_dwordx4 v6, s[12:15], s22 offen offset:1024 lds
  s_add_u32 s22, s22, 16384
  buffer_load_dwordx4 a[24:27], v2, s[8:11], s21 offen
  buffer_load_dwordx4 a[28:31], v3, s[8:11], s21 offen
  buffer_load_dwordx4 a[32:35], v4, s[8:11], s21 offen
  s_add_u32 m0, s23, 4096
  s_add_u32 s21, s21, 1024
  buffer_load_dwordx4 v5, s[12:15], s22 offen lds
  buffer_load_dwordx4 v6, s[12:15], s22 offen offset:1024 lds
  s_add_u32 s22, s22, 16384
  buffer_load_dwordx4 a[36:39], v2, s[8:11], s21 offen
  buffer_load_dwordx4 a[40:43], v3, s[8:11], s21 offen
  buffer_load_dwordx4 a[44:47], v4, s[8:11], s21 offen
  s_add_u32 m0, s23, 6144
  s_add_u32 s21, s21, 1024
  buffer_load_dwordx4 v5, s[12:15], s22 offen lds
  buffer_load_dwordx4 v6, s[12:15], s22 offen offset:1024 lds
  s_add_u32 s22, s22, 16384
  buffer_load_dwordx4 a[48:51], v2, s[8:11], s21 offen
  buffer_load_dwordx4 a[52:55], v3, s[8:11], s21 offen
  buffer_load_dwordx4 a[56:59], v4, s[8:11], s21 offen
  s_add_u32 m0, s23, 8192
  s_add_u32 s21, s21, 1024
  buffer_load_dwordx4 v5, s[12:15], s22 offen lds
  buffer_load_dwordx4 v6, s[12:15], s22 offen offset:1024 lds
  s_add_u32 s22, s22, 16384
  s_mul_i32 s7, s5, 196608
  s_lshl_b32 s25, s3, 10
  s_add_u32 s7, s7, s25
  s_lshl_b32 s25, s6, 7
  s_add_u32 s7, s7, s25
  s_add_u32 s16, s32, s7
  s_addc_u32 s17, s33, 0
  s_and_b32 s17, s17, 0xffff
  s_mov_b32 s18, 196608
  s_mov_b32 s19, 0x20000
  v_and_b32 v12, 31, v0
  v_lshrrev_b32 v13, 5, v0
  v_lshlrev_b32 v14, 4, v13
  v_lshl_add_u32 v11, v12, 11, v14
  s_lshl_b32 s7, s20, 5
  v_add_u32 v11, s7, v11
  v_bfe_u32 v12, v0, 2, 2
  v_lshl_add_u32 v14, v13, 3, v12
  v_lshlrev_b32 v14, 7, v14
  v_bfe_u32 v15, v0, 3, 1
  v_lshl_or_b32 v14, v15, 6, v14
  v_bfe_u32 v15, v0, 4, 1
  v_lshl_or_b32 v14, v15, 5, v14
  v_and_b32 v15, 1, v0
  v_lshl_or_b32 v14, v15, 4, v14
  v_bfe_u32 v15, v0, 1, 1
  v_lshl_or_b32 v14, v15, 3, v14
  v_add_u32 v7, s23, v14
  v_xor_b32 v8, 64, v7
  v_lshlrev_b32 v12, 4, v0
  v_add_u32 v10, s23, v12
  s_mul_i32 s7, s20, 6144
  v_add_u32 v9, s7, v12
  v_mov_b32 v64, 0
  v_mov_b32 v65, 0
  v_mov_b32 v66, 0
  v_mov_b32 v67, 0
  v_mov_b32 v68, 0
  v_mov_b32 v69, 0
  v_mov_b32 v70, 0
  v_mov_b32 v71, 0
  v_mov_b32 v72, 0
  v_mov_b32 v73, 0
  v_mov_b32 v74, 0
  v_mov_b32 v75, 0
  v_mov_b32 v76, 0
  v_mov_b32 v77, 0
  v_mov_b32 v78, 0
  v_mov_b32 v79, 0
  v_mov_b32 v80, 0
  v_mov_b32 v81, 0
  v_mov_b32 v82, 0
  v_mov_b32 v83, 0
  v_mov_b32 v84, 0
  v_mov_b32 v85, 0
  v_mov_b32 v86, 0
  v_mov_b32 v87, 0
  v_mov_b32 v88, 0
  v_mov_b32 v89, 0
  v_mov_b32 v90, 0
  v_mov_b32 v91, 0
  v_mov_b32 v92, 0
  v_mov_b32 v93, 0
  v_mov_b32 v94, 0
  v_mov_b32 v95, 0
  v_mov_b32 v96, 0
  v_mov_b32 v97, 0
  v_mov_b32 v98, 0
  v_mov_b32 v99, 0
  v_mov_b32 v100, 0
  v_mov_b32 v101, 0
  v_mov_b32 v102, 0
  v_mov_b32 v103, 0
  v_mov_b32 v104, 0
  v_mov_b32 v105, 0
  v_mov_b32 v106, 0
  v_mov_b32 v107, 0
  v_mov_b32 v108, 0
  v_mov_b32 v109, 0
  v_mov_b32 v110, 0
  v_mov_b32 v111, 0
  v_mov_b32 v112, 0
  v_mov_b32 v113, 0
  v_mov_b32 v114, 0
  v_mov_b32 v115, 0
  v_mov_b32 v116, 0
  v_mov_b32 v117, 0
  v_mov_b32 v118, 0
  v_mov_b32 v119, 0
  v_mov_b32 v120, 0
  v_mov_b32 v121, 0
  v_mov_b32 v122, 0
  v_mov_b32 v123, 0
  v_mov_b32 v124, 0
  v_mov_b32 v125, 0
  v_mov_b32 v126, 0
  v_mov_b32 v127, 0
  v_mov_b32 v128, 0
  v_mov_b32 v129, 0
  v_mov_b32 v130, 0
  v_mov_b32 v131, 0
  v_mov_b32 v132, 0
  v_mov_b32 v133, 0
  v_mov_b32 v134, 0
  v_mov_b32 v135, 0
  v_mov_b32 v136, 0
  v_mov_b32 v137, 0
  v_mov_b32 v138, 0
  v_mov_b32 v139, 0
  v_mov_b32 v140, 0
  v_mov_b32 v141, 0
  v_mov_b32 v142, 0
  v_mov_b32 v143, 0
  v_mov_b32 v144, 0
  v_mov_b32 v145, 0
  v_mov_b32 v146, 0
  v_mov_b32 v147, 0
  v_mov_b32 v148, 0
  v_mov_b32 v149, 0
  v_mov_b32 v150, 0
  v_mov_b32 v151, 0
  v_mov_b32 v152, 0
  v_mov_b32 v153, 0
  v_mov_b32 v154, 0
  v_mov_b32 v155, 0
  v_mov_b32 v156, 0
  v_mov_b32 v157, 0
  v_mov_b32 v158, 0
  v_mov_b32 v159, 0
  s_waitcnt vmcnt(20)
  ds_read_b64_tr_b16 a[192:193], v7 offset:0
  ds_read_b64_tr_b16 a[194:195], v7 offset:512
  ds_read_b64_tr_b16 a[196:197], v8 offset:0
  ds_read_b64_tr_b16 a[198:199], v8 offset:512
  s_mov_b32 s24, 0
k2_loop:
  s_waitcnt lgkmcnt(0)
  v_mfma_f32_32x32x16_bf16 v[64:79], a[192:195], a[0:3], v[64:79]
  s_waitcnt vmcnt(15)
  ds_read_b64_tr_b16 a[200:201], v7 offset:2048
  ds_read_b64_tr_b16 a[202:203], v7 offset:2560
  v_mfma_f32_32x32x16_bf16 v[80:95], a[192:195], a[4:7], v[80:95]
  ds_read_b64_tr_b16 a[204:205], v8 offset:2048
  ds_read_b64_tr_b16 a[206:207], v8 offset:2560
  buffer_load_dwordx4 a[60:63], v2, s[8:11], s21 offen
  v_mfma_f32_32x32x16_bf16 v[96:111], a[192:195], a[8:11], v[96:111]
  buffer_load_dwordx4 a[64:67], v3, s[8:11], s21 offen
  v_mfma_f32_32x32x16_bf16 v[112:127], a[196:199], a[0:3], v[112:127]
  buffer_load_dwordx4 a[68:71], v4, s[8:11], s21 offen
  v_mfma_f32_32x32x16_bf16 v[128:143], a[196:199], a[4:7], v[128:143]
  s_add_u32 m0, s23, 10240
  s_add_u32 s21, s21, 1024
  buffer_load_dwordx4 v5, s[12:15], s22 offen lds
  v_mfma_f32_32x32x16_bf16 v[144:159], a[196:199], a[8:11], v[144:159]
  buffer_load_dwordx4 v6, s[12:15], s22 offen offset:1024 lds
  s_add_u32 s22, s22, 16384
  s_waitcnt lgkmcnt(0)
  v_mfma_f32_32x32x16_bf16 v[64:79], a[200:203], a[12:15], v[64:79]
  s_waitcnt vmcnt(15)
  ds_read_b64_tr_b16 a[192:193], v7 offset:4096
  ds_read_b64_tr_b16 a[194:195], v7 offset:4608
  v_mfma_f32_32x32x16_bf16 v[80:95], a[200:203], a[16:19], v[80:95]
  ds_read_b64_tr_b16 a[196:197], v8 offset:4096
  ds_read_b64_tr_b16 a[198:199], v8 offset:4608
  buffer_load_dwordx4 a[72:75], v2, s[8:11], s21 offen
  v_mfma_f32_32x32x16_bf16 v[96:111], a[200:203], a[20:23], v[96:111]
  buffer_load_dwordx4 a[76:79], v3, s[8:11], s21 offen
  v_mfma_f32_32x32x16_bf16 v[112:127], a[204:207], a[12:15], v[112:127]
  buffer_load_dwordx4 a[80:83], v4, s[8:11], s21 offen
  v_mfma_f32_32x32x16_bf16 v[128:143], a[204:207], a[16:19], v[128:143]
  s_add_u32 m0, s23, 12288
  s_add_u32 s21, s21, 1024
  buffer_load_dwordx4 v5, s[12:15], s22 offen lds
  v_mfma_f32_32x32x16_bf16 v[144:159], a[204:207], a[20:23], v[144:159]
  buffer_load_dwordx4 v6, s[12:15], s22 offen offset:1024 lds
  s_add_u32 s22, s22, 16384
  s_waitcnt lgkmcnt(0)
  v_mfma_f32_32x32x16_bf16 v[64:79], a[192:195], a[24:27], v[64:79]
  s_waitcnt vmcnt(15)
  ds_read_b64_tr_b16 a[200:201], v7 offset:6144
  ds_read_b64_tr_b16 a[202:203], v7 offset:6656
  v_mfma_f32_32x32x16_bf16 v[80:95], a[192:195], a[28:31], v[80:95]
  ds_read_b64_tr_b16 a[204:205], v8 offset:6144
  ds_read_b64_tr_b16 a[206:207], v8 offset:6656
  buffer_load_dwordx4 a[84:87], v2, s[8:11], s21 offen
  v_mfma_f32_32x32x16_bf16 v[96:111], a[192:195], a[32:35], v[96:111]
  buffer_load_dwordx4 a[88:91], v3, s[8:11], s21 offen
  v_mfma_f32_32x32x16_bf16 v[112:127], a[196:199], a[24:27], v[112:127]
  buffer_load_dwordx4 a[92:95], v4, s[8:11], s21 offen
  v_mfma_f32_32x32x16_bf16 v[128:143], a[196:199], a[28:31], v[128:143]
  s_add_u32 m0, s23, 14336
  s_add_u32 s21, s21, 1024
  buffer_load_dwordx4 v5, s[12:15], s22 offen lds
  v_mfma_f32_32x32x16_bf16 v[144:159], a[196:199], a[32:35], v[144:159]
  buffer_load_dwordx4 v6, s[12:15], s22 offen offset:1024 lds
  s_add_u32 s22, s22, 16384
  s_waitcnt lgkmcnt(0)
  v_mfma_f32_32x32x16_bf16 v[64:79], a[200:203], a[36:39], v[64:79]
  s_waitcnt vmcnt(15)
  ds_read_b64_tr_b16 a[192:193], v7 offset:8192
  ds_read_b64_tr_b16 a[194:195], v7 offset:8704
  v_mfma_f32_32x32x16_bf16 v[80:95], a[200:203], a[40:43], v[80:95]
  ds_read_b64_tr_b16 a[196:197], v8 offset:8192
  ds_read_b64_tr_b16 a[198:199], v8 offset:8704
  buffer_load_dwordx4 a[96:99], v2, s[8:11], s21 offen
  v_mfma_f32_32x32x16_bf16 v[96:111], a[200:203], a[44:47], v[96:111]
  buffer_load_dwordx4 a[100:103], v3, s[8:11], s21 offen
  v_mfma_f32_32x32x16_bf16 v[112:127], a[204:207], a[36:39], v[112:127]
  buffer_load_dwordx4 a[104:107], v4, s[8:11], s21 offen
  v_mfma_f32_32x32x16_bf16 v[128:143], a[204:207], a[40:43], v[128:143]
  s_add_u32 m0, s23, 16384
  s_add_u32 s21, s21, 1024
  buffer_load_dwordx4 v5, s[12:15], s22 offen lds
  v_mfma_f32_32x32x16_bf16 v[144:159], a[204:207], a[44:47], v[144:159]
  buffer_load_dwordx4 v6, s[12:15], s22 offen offset:1024 lds
  s_add_u32 s22, s22, 16384
  s_waitcnt lgkmcnt(0)
  v_mfma_f32_32x32x16_bf16 v[64:79], a[192:195], a[48:51], v[64:79]
  s_waitcnt vmcnt(15)
  ds_read_b64_tr_b16 a[200:201], v7 offset:10240
  ds_read_b64_tr_b16 a[202:203], v7 offset:10752
  v_mfma_f32_32x32x16_bf16 v[80:95], a[192:195], a[52:55], v[80:95]
  ds_read_b64_tr_b16 a[204:205], v8 offset:10240
  ds_read_b64_tr_b16 a[206:207], v8 offset:10752
  buffer_load_dwordx4 a[108:111], v2, s[8:11], s21 offen
  v_mfma_f32_32x32x16_bf16 v[96:111], a[192:195], a[56:59], v[96:111]
  buffer_load_dwordx4 a[112:115], v3, s[8:11], s21 offen
  v_mfma_f32_32x32x16_bf16 v[112:127], a[196:199], a[48:51], v[112:127]
  buffer_load_dwordx4 a[116:119], v4, s[8:11], s21 offen
  v_mfma_f32_32x32x16_bf16 v[128:143], a[196:199], a[52:55], v[128:143]
  s_add_u32 m0, s23, 18432
  s_add_u32 s21, s21, 1024
  buffer_load_dwordx4 v5, s[12:15], s22 offen lds
  v_mfma_f32_32x32x16_bf16 v[144:159], a[196:199], a[56:59], v[144:159]
  buffer_load_dwordx4 v6, s[12:15], s22 offen offset:1024 lds
  s_add_u32 s22, s22, 16384
  s_waitcnt lgkmcnt(0)
  v_mfma_f32_32x32x16_bf16 v[64:79], a[200:203], a[60:63], v[64:79]
  s_waitcnt vmcnt(15)
  ds_read_b64_tr_b16 a[192:193], v7 offset:12288
  ds_read_b64_tr_b16 a[194:195], v7 offset:12800
  v_mfma_f32_32x32x16_bf16 v[80:95], a[200:203], a[64:67], v[80:95]
  ds_read_b64_tr_b16 a[196:197], v8 offset:12288
  ds_read_b64_tr_b16 a[198:199], v8 offset:12800
  buffer_load_dwordx4 a[120:123], v2, s[8:11], s21 offen
  v_mfma_f32_32x32x16_bf16 v[96:111], a[200:203], a[68:71], v[96:111]
  buffer_load_dwordx4 a[124:127], v3, s[8:11], s21 offen
  v_mfma_f32_32x32x16_bf16 v[112:127], a[204:207], a[60:63], v[112:127]
  buffer_load_dwordx4 a[128:131], v4, s[8:11], s21 offen
  v_mfma_f32_32x32x16_bf16 v[128:143], a[204:207], a[64:67], v[128:143]
  s_add_u32 m0, s23, 20480
  s_add_u32 s21, s21, 1024
  buffer_load_dwordx4 v5, s[12:15], s22 offen lds
  v_mfma_f32_32x32x16_bf16 v[144:159], a[204:207], a[68:71], v[144:159]
  buffer_load_dwordx4 v6, s[12:15], s22 offen offset:1024 lds
  s_add_u32 s22, s22, 16384
  s_waitcnt lgkmcnt(0)
  v_mfma_f32_32x32x16_bf16 v[64:79], a[192:195], a[72:75], v[64:79]
  s_waitcnt vmcnt(15)
  ds_read_b64_tr_b16 a[200:201], v7 offset:14336
  ds_read_b64_tr_b16 a[202:203], v7 offset:14848
  v_mfma_f32_32x32x16_bf16 v[80:95], a[192:195], a[76:79], v[80:95]
  ds_read_b64_tr_b16 a[204:205], v8 offset:14336
  ds_read_b64_tr_b16 a[206:207], v8 offset:14848
  buffer_load_dwordx4 a[132:135], v2, s[8:11], s21 offen
  v_mfma_f32_32x32x16_bf16 v[96:111], a[192:195], a[80:83], v[96:111]
  buffer_load_dwordx4 a[136:139], v3, s[8:11], s21 offen
  v_mfma_f32_32x32x16_bf16 v[112:127], a[196:199], a[72:75], v[112:127]
  buffer_load_dwordx4 a[140:143], v4, s[8:11], s21 offen
  v_mfma_f32_32x32x16_bf16 v[128:143], a[196:199], a[76:79], v[128:143]
  s_add_u32 m0, s23, 22528
  s_add_u32 s21, s21, 1024
  buffer_load_dwordx4 v5, s[12:15], s22 offen lds
  v_mfma_f32_32x32x16_bf16 v[144:159], a[196:199], a[80:83], v[144:159]
  buffer_load_dwordx4 v6, s[12:15], s22 offen offset:1024 lds
  s_add_u32 s22, s22, 16384
  s_waitcnt lgkmcnt(0)
  v_mfma_f32_32x32x16_bf16 v[64:79], a[200:203], a[84:87], v[64:79]
  s_waitcnt vmcnt(15)
  ds_read_b64_tr_b16 a[192:193], v7 offset:16384
  ds_read_b64_tr_b16 a[194:195], v7 offset:16896
  v_mfma_f32_32x32x16_bf16 v[80:95], a[200:203], a[88:91], v[80:95]
  ds_read_b64_tr_b16 a[196:197], v8 offset:16384
  ds_read_b64_tr_b16 a[198:199], v8 offset:16896
  buffer_load_dwordx4 a[144:147], v2, s[8:11], s21 offen
  v_mfma_f32_32x32x16_bf16 v[96:111], a[200:203], a[92:95], v[96:111]
  buffer_load_dwordx4 a[148:151], v3, s[8:11], s21 offen
  v_mfma_f32_32x32x16_bf16 v[112:127], a[204:207], a[84:87], v[112:127]
  buffer_load_dwordx4 a[152:155], v4, s[8:11], s21 offen
  v_mfma_f32_32x32x16_bf16 v[128:143], a[204:207], a[88:91], v[128:143]
  s_add_u32 m0, s23, 24576
  s_add_u32 s21, s21, 1024
  buffer_load_dwordx4 v5, s[12:15], s22 offen lds
  v_mfma_f32_32x32x16_bf16 v[144:159], a[204:207], a[92:95], v[144:159]
  buffer_load_dwordx4 v6, s[12:15], s22 offen offset:1024 lds
  s_add_u32 s22, s22, 16384
  s_waitcnt lgkmcnt(0)
  v_mfma_f32_32x32x16_bf16 v[64:79], a[192:195], a[96:99], v[64:79]
  s_waitcnt vmcnt(15)
  ds_read_b64_tr_b16 a[200:201], v7 offset:18432
  ds_read_b64_tr_b16 a[202:203], v7 offset:18944
  v_mfma_f32_32x32x16_bf16 v[80:95], a[192:195], a[100:103], v[80:95]
  ds_read_b64_tr_b16 a[204:205], v8 offset:18432
  ds_read_b64_tr_b16 a[206:207], v8 offset:18944
  buffer_load_dwordx4 a[156:159], v2, s[8:11], s21 offen
  v_mfma_f32_32x32x16_bf16 v[96:111], a[192:195], a[104:107], v[96:111]
  buffer_load_dwordx4 a[160:163], v3, s[8:11], s21 offen
  v_mfma_f32_32x32x16_bf16 v[112:127], a[196:199], a[96:99], v[112:127]
  buffer_load_dwordx4 a[164:167], v4, s[8:11], s21 offen
  v_mfma_f32_32x32x16_bf16 v[128:143], a[196:199], a[100:103], v[128:143]
  s_add_u32 m0, s23, 26624
  s_add_u32 s21, s21, 1024
  buffer_load_dwordx4 v5, s[12:15], s22 offen lds
  v_mfma_f32_32x32x16_bf16 v[144:159], a[196:199], a[104:107], v[144:159]
  buffer_load_dwordx4 v6, s[12:15], s22 offen offset:1024 lds
  s_add_u32 s22, s22, 16384
  s_waitcnt lgkmcnt(0)
  v_mfma_f32_32x32x16_bf16 v[64:79], a[200:203], a[108:111], v[64:79]
  s_waitcnt vmcnt(15)
  ds_read_b64_tr_b16 a[192:193], v7 offset:20480
  ds_read_b64_tr_b16 a[194:195], v7 offset:20992
  v_mfma_f32_32x32x16_bf16 v[80:95], a[200:203], a[112:115], v[80:95]
  ds_read_b64_tr_b16 a[196:197], v8 offset:20480
  ds_read_b64_tr_b16 a[198:199], v8 offset:20992
  buffer_load_dwordx4 a[168:171], v2, s[8:11], s21 offen
  v_mfma_f32_32x32x16_bf16 v[96:111], a[200:203], a[116:119], v[96:111]
  buffer_load_dwordx4 a[172:175], v3, s[8:11], s21 offen
  v_mfma_f32_32x32x16_bf16 v[112:127], a[204:207], a[108:111], v[112:127]
  buffer_load_dwordx4 a[176:179], v4, s[8:11], s21 offen
  v_mfma_f32_32x32x16_bf16 v[128:143], a[204:207], a[112:115], v[128:143]
  s_add_u32 m0, s23, 28672
  s_add_u32 s21, s21, 1024
  buffer_load_dwordx4 v5, s[12:15], s22 offen lds
  v_mfma_f32_32x32x16_bf16 v[144:159], a[204:207], a[116:119], v[144:159]
  buffer_load_dwordx4 v6, s[12:15], s22 offen offset:1024 lds
  s_add_u32 s22, s22, 16384
  s_waitcnt lgkmcnt(0)
  v_mfma_f32_32x32x16_bf16 v[64:79], a[192:195], a[120:123], v[64:79]
  s_waitcnt vmcnt(15)
  ds_read_b64_tr_b16 a[200:201], v7 offset:22528
  ds_read_b64_tr_b16 a[202:203], v7 offset:23040
  v_mfma_f32_32x32x16_bf16 v[80:95], a[192:195], a[124:127], v[80:95]
  ds_read_b64_tr_b16 a[204:205], v8 offset:22528
  ds_read_b64_tr_b16 a[206:207], v8 offset:23040
  buffer_load_dwordx4 a[180:183], v2, s[8:11], s21 offen
  v_mfma_f32_32x32x16_bf16 v[96:111], a[192:195], a[128:131], v[96:111]
  buffer_load_dwordx4 a[184:187], v3, s[8:11], s21 offen
  v_mfma_f32_32x32x16_bf16 v[112:127], a[196:199], a[120:123], v[112:127]
  buffer_load_dwordx4 a[188:191], v4, s[8:11], s21 offen
  v_mfma_f32_32x32x16_bf16 v[128:143], a[196:199], a[124:127], v[128:143]
  s_add_u32 m0, s23, 30720
  s_add_u32 s21, s21, 1024
  buffer_load_dwordx4 v5, s[12:15], s22 offen lds
  v_mfma_f32_32x32x16_bf16 v[144:159], a[196:199], a[128:131], v[144:159]
  buffer_load_dwordx4 v6, s[12:15], s22 offen offset:1024 lds
  s_add_u32 s22, s22, 16384
  s_waitcnt lgkmcnt(0)
  v_mfma_f32_32x32x16_bf16 v[64:79], a[200:203], a[132:135], v[64:79]
  s_waitcnt vmcnt(15)
  ds_read_b64_tr_b16 a[192:193], v7 offset:24576
  ds_read_b64_tr_b16 a[194:195], v7 offset:25088
  v_mfma_f32_32x32x16_bf16 v[80:95], a[200:203], a[136:139], v[80:95]
  ds_read_b64_tr_b16 a[196:197], v8 offset:24576
  ds_read_b64_tr_b16 a[198:199], v8 offset:25088
  buffer_load_dwordx4 a[0:3], v2, s[8:11], s21 offen
  v_mfma_f32_32x32x16_bf16 v[96:111], a[200:203], a[140:143], v[96:111]
  buffer_load_dwordx4 a[4:7], v3, s[8:11], s21 offen
  v_mfma_f32_32x32x16_bf16 v[112:127], a[204:207], a[132:135], v[112:127]
  buffer_load_dwordx4 a[8:11], v4, s[8:11], s21 offen
  v_mfma_f32_32x32x16_bf16 v[128:143], a[204:207], a[136:139], v[128:143]
  s_add_u32 m0, s23, 0
  s_add_u32 s21, s21, 1024
  buffer_load_dwordx4 v5, s[12:15], s22 offen lds
  v_mfma_f32_32x32x16_bf16 v[144:159], a[204:207], a[140:143], v[144:159]
  buffer_load_dwordx4 v6, s[12:15], s22 offen offset:1024 lds
  s_add_u32 s22, s22, 16384
  s_waitcnt lgkmcnt(0)
  v_mfma_f32_32x32x16_bf16 v[64:79], a[192:195], a[144:147], v[64:79]
  s_waitcnt vmcnt(15)
  ds_read_b64_tr_b16 a[200:201], v7 offset:26624
  ds_read_b64_tr_b16 a[202:203], v7 offset:27136
  v_mfma_f32_32x32x16_bf16 v[80:95], a[192:195], a[148:151], v[80:95]
  ds_read_b64_tr_b16 a[204:205], v8 offset:26624
  ds_read_b64_tr_b16 a[206:207], v8 offset:27136
  buffer_load_dwordx4 a[12:15], v2, s[8:11], s21 offen
  v_mfma_f32_32x32x16_bf16 v[96:111], a[192:195], a[152:155], v[96:111]
  buffer_load_dwordx4 a[16:19], v3, s[8:11], s21 offen
  v_mfma_f32_32x32x16_bf16 v[112:127], a[196:199], a[144:147], v[112:127]
  buffer_load_dwordx4 a[20:23], v4, s[8:11], s21 offen
  v_mfma_f32_32x32x16_bf16 v[128:143], a[196:199], a[148:151], v[128:143]
  s_add_u32 m0, s23, 2048
  s_add_u32 s21, s21, 1024
  buffer_load_dwordx4 v5, s[12:15], s22 offen lds
  v_mfma_f32_32x32x16_bf16 v[144:159], a[196:199], a[152:155], v[144:159]
  buffer_load_dwordx4 v6, s[12:15], s22 offen offset:1024 lds
  s_add_u32 s22, s22, 16384
  s_waitcnt lgkmcnt(0)
  v_mfma_f32_32x32x16_bf16 v[64:79], a[200:203], a[156:159], v[64:79]
  s_waitcnt vmcnt(15)
  ds_read_b64_tr_b16 a[192:193], v7 offset:28672
  ds_read_b64_tr_b16 a[194:195], v7 offset:29184
  v_mfma_f32_32x32x16_bf16 v[80:95], a[200:203], a[160:163], v[80:95]
  ds_read_b64_tr_b16 a[196:197], v8 offset:28672
  ds_read_b64_tr_b16 a[198:199], v8 offset:29184
  buffer_load_dwordx4 a[24:27], v2, s[8:11], s21 offen
  v_mfma_f32_32x32x16_bf16 v[96:111], a[200:203], a[164:167], v[96:111]
  buffer_load_dwordx4 a[28:31], v3, s[8:11], s21 offen
  v_mfma_f32_32x32x16_bf16 v[112:127], a[204:207], a[156:159], v[112:127]
  buffer_load_dwordx4 a[32:35], v4, s[8:11], s21 offen
  v_mfma_f32_32x32x16_bf16 v[128:143], a[204:207], a[160:163], v[128:143]
  s_add_u32 m0, s23, 4096
  s_add_u32 s21, s21, 1024
  buffer_load_dwordx4 v5, s[12:15], s22 offen lds
  v_mfma_f32_32x32x16_bf16 v[144:159], a[204:207], a[164:167], v[144:159]
  buffer_load_dwordx4 v6, s[12:15], s22 offen offset:1024 lds
  s_add_u32 s22, s22, 16384
  s_waitcnt lgkmcnt(0)
  v_mfma_f32_32x32x16_bf16 v[64:79], a[192:195], a[168:171], v[64:79]
  s_waitcnt vmcnt(15)
  ds_read_b64_tr_b16 a[200:201], v7 offset:30720
  ds_read_b64_tr_b16 a[202:203], v7 offset:31232
  v_mfma_f32_32x32x16_bf16 v[80:95], a[192:195], a[172:175], v[80:95]
  ds_read_b64_tr_b16 a[204:205], v8 offset:30720
  ds_read_b64_tr_b16 a[206:207], v8 offset:31232
  buffer_load_dwordx4 a[36:39], v2, s[8:11], s21 offen
  v_mfma_f32_32x32x16_bf16 v[96:111], a[192:195], a[176:179], v[96:111]
  buffer_load_dwordx4 a[40:43], v3, s[8:11], s21 offen
  v_mfma_f32_32x32x16_bf16 v[112:127], a[196:199], a[168:171], v[112:127]
  buffer_load_dwordx4 a[44:47], v4, s[8:11], s21 offen
  v_mfma_f32_32x32x16_bf16 v[128:143], a[196:199], a[172:175], v[128:143]
  s_add_u32 m0, s23, 6144
  s_add_u32 s21, s21, 1024
  buffer_load_dwordx4 v5, s[12:15], s22 offen lds
  v_mfma_f32_32x32x16_bf16 v[144:159], a[196:199], a[176:179], v[144:159]
  buffer_load_dwordx4 v6, s[12:15], s22 offen offset:1024 lds
  s_add_u32 s22, s22, 16384
  s_waitcnt lgkmcnt(0)
  v_mfma_f32_32x32x16_bf16 v[64:79], a[200:203], a[180:183], v[64:79]
  s_waitcnt vmcnt(15)
  ds_read_b64_tr_b16 a[192:193], v7 offset:0
  ds_read_b64_tr_b16 a[194:195], v7 offset:512
  v_mfma_f32_32x32x16_bf16 v[80:95], a[200:203], a[184:187], v[80:95]
  ds_read_b64_tr_b16 a[196:197], v8 offset:0
  ds_read_b64_tr_b16 a[198:199], v8 offset:512
  buffer_load_dwordx4 a[48:51], v2, s[8:11], s21 offen
  v_mfma_f32_32x32x16_bf16 v[96:111], a[200:203], a[188:191], v[96:111]
  buffer_load_dwordx4 a[52:55], v3, s[8:11], s21 offen
  v_mfma_f32_32x32x16_bf16 v[112:127], a[204:207], a[180:183], v[112:127]
  buffer_load_dwordx4 a[56:59], v4, s[8:11], s21 offen
  v_mfma_f32_32x32x16_bf16 v[128:143], a[204:207], a[184:187], v[128:143]
  s_add_u32 m0, s23, 8192
  s_add_u32 s21, s21, 1024
  buffer_load_dwordx4 v5, s[12:15], s22 offen lds
  v_mfma_f32_32x32x16_bf16 v[144:159], a[204:207], a[188:191], v[144:159]
  buffer_load_dwordx4 v6, s[12:15], s22 offen offset:1024 lds
  s_add_u32 s22, s22, 16384
  s_add_u32 s24, s24, 1
  s_cmp_lt_u32 s24, 3
  s_cbranch_scc1 k2_loop
  s_waitcnt lgkmcnt(0)
  v_mfma_f32_32x32x16_bf16 v[64:79], a[192:195], a[0:3], v[64:79]
  s_waitcnt vmcnt(15)
  ds_read_b64_tr_b16 a[200:201], v7 offset:2048
  ds_read_b64_tr_b16 a[202:203], v7 offset:2560
  v_mfma_f32_32x32x16_bf16 v[80:95], a[192:195], a[4:7], v[80:95]
  ds_read_b64_tr_b16 a[204:205], v8 offset:2048
  ds_read_b64_tr_b16 a[206:207], v8 offset:2560
  buffer_load_dwordx4 a[60:63], v2, s[8:11], s21 offen
  v_mfma_f32_32x32x16_bf16 v[96:111], a[192:195], a[8:11], v[96:111]
  buffer_load_dwordx4 a[64:67], v3, s[8:11], s21 offen
  v_mfma_f32_32x32x16_bf16 v[112:127], a[196:199], a[0:3], v[112:127]
  buffer_load_dwordx4 a[68:71], v4, s[8:11], s21 offen
  v_mfma_f32_32x32x16_bf16 v[128:143], a[196:199], a[4:7], v[128:143]
  s_add_u32 m0, s23, 10240
  s_add_u32 s21, s21, 1024
  buffer_load_dwordx4 v5, s[12:15], s22 offen lds
  v_mfma_f32_32x32x16_bf16 v[144:159], a[196:199], a[8:11], v[144:159]
  buffer_load_dwordx4 v6, s[12:15], s22 offen offset:1024 lds
  s_add_u32 s22, s22, 16384
  s_waitcnt lgkmcnt(0)
  v_mfma_f32_32x32x16_bf16 v[64:79], a[200:203], a[12:15], v[64:79]
  s_waitcnt vmcnt(15)
  ds_read_b64_tr_b16 a[192:193], v7 offset:4096
  ds_read_b64_tr_b16 a[194:195], v7 offset:4608
  v_mfma_f32_32x32x16_bf16 v[80:95], a[200:203], a[16:19], v[80:95]
  ds_read_b64_tr_b16 a[196:197], v8 offset:4096
  ds_read_b64_tr_b16 a[198:199], v8 offset:4608
  buffer_load_dwordx4 a[72:75], v2, s[8:11], s21 offen
  v_mfma_f32_32x32x16_bf16 v[96:111], a[200:203], a[20:23], v[96:111]
  buffer_load_dwordx4 a[76:79], v3, s[8:11], s21 offen
  v_mfma_f32_32x32x16_bf16 v[112:127], a[204:207], a[12:15], v[112:127]
  buffer_load_dwordx4 a[80:83], v4, s[8:11], s21 offen
  v_mfma_f32_32x32x16_bf16 v[128:143], a[204:207], a[16:19], v[128:143]
  s_add_u32 m0, s23, 12288
  s_add_u32 s21, s21, 1024
  buffer_load_dwordx4 v5, s[12:15], s22 offen lds
  v_mfma_f32_32x32x16_bf16 v[144:159], a[204:207], a[20:23], v[144:159]
  buffer_load_dwordx4 v6, s[12:15], s22 offen offset:1024 lds
  s_add_u32 s22, s22, 16384
  s_waitcnt lgkmcnt(0)
  v_mfma_f32_32x32x16_bf16 v[64:79], a[192:195], a[24:27], v[64:79]
  s_waitcnt vmcnt(15)
  ds_read_b64_tr_b16 a[200:201], v7 offset:6144
  ds_read_b64_tr_b16 a[202:203], v7 offset:6656
  v_mfma_f32_32x32x16_bf16 v[80:95], a[192:195], a[28:31], v[80:95]
  ds_read_b64_tr_b16 a[204:205], v8 offset:6144
  ds_read_b64_tr_b16 a[206:207], v8 offset:6656
  buffer_load_dwordx4 a[84:87], v2, s[8:11], s21 offen
  v_mfma_f32_32x32x16_bf16 v[96:111], a[192:195], a[32:35], v[96:111]
  buffer_load_dwordx4 a[88:91], v3, s[8:11], s21 offen
  v_mfma_f32_32x32x16_bf16 v[112:127], a[196:199], a[24:27], v[112:127]
  buffer_load_dwordx4 a[92:95], v4, s[8:11], s21 offen
  v_mfma_f32_32x32x16_bf16 v[128:143], a[196:199], a[28:31], v[128:143]
  s_add_u32 m0, s23, 14336
  s_add_u32 s21, s21, 1024
  buffer_load_dwordx4 v5, s[12:15], s22 offen lds
  v_mfma_f32_32x32x16_bf16 v[144:159], a[196:199], a[32:35], v[144:159]
  buffer_load_dwordx4 v6, s[12:15], s22 offen offset:1024 lds
  s_add_u32 s22, s22, 16384
  s_waitcnt lgkmcnt(0)
  v_mfma_f32_32x32x16_bf16 v[64:79], a[200:203], a[36:39], v[64:79]
  s_waitcnt vmcnt(15)
  ds_read_b64_tr_b16 a[192:193], v7 offset:8192
  ds_read_b64_tr_b16 a[194:195], v7 offset:8704
  v_mfma_f32_32x32x16_bf16 v[80:95], a[200:203], a[40:43], v[80:95]
  ds_read_b64_tr_b16 a[196:197], v8 offset:8192
  ds_read_b64_tr_b16 a[198:199], v8 offset:8704
  buffer_load_dwordx4 a[96:99], v2, s[8:11], s21 offen
  v_mfma_f32_32x32x16_bf16 v[96:111], a[200:203], a[44:47], v[96:111]
  buffer_load_dwordx4 a[100:103], v3, s[8:11], s21 offen
  v_mfma_f32_32x32x16_bf16 v[112:127], a[204:207], a[36:39], v[112:127]
  buffer_load_dwordx4 a[104:107], v4, s[8:11], s21 offen
  v_mfma_f32_32x32x16_bf16 v[128:143], a[204:207], a[40:43], v[128:143]
  s_add_u32 m0, s23, 16384
  s_add_u32 s21, s21, 1024
  buffer_load_dwordx4 v5, s[12:15], s22 offen lds
  v_mfma_f32_32x32x16_bf16 v[144:159], a[204:207], a[44:47], v[144:159]
  buffer_load_dwordx4 v6, s[12:15], s22 offen offset:1024 lds
  s_add_u32 s22, s22, 16384
  s_waitcnt lgkmcnt(0)
  v_mfma_f32_32x32x16_bf16 v[64:79], a[192:195], a[48:51], v[64:79]
  s_waitcnt vmcnt(15)
  ds_read_b64_tr_b16 a[200:201], v7 offset:10240
  ds_read_b64_tr_b16 a[202:203], v7 offset:10752
  v_mfma_f32_32x32x16_bf16 v[80:95], a[192:195], a[52:55], v[80:95]
  ds_read_b64_tr_b16 a[204:205], v8 offset:10240
  ds_read_b64_tr_b16 a[206:207], v8 offset:10752
  buffer_load_dwordx4 a[108:111], v2, s[8:11], s21 offen
  v_mfma_f32_32x32x16_bf16 v[96:111], a[192:195], a[56:59], v[96:111]
  buffer_load_dwordx4 a[112:115], v3, s[8:11], s21 offen
  v_mfma_f32_32x32x16_bf16 v[112:127], a[196:199], a[48:51], v[112:127]
  buffer_load_dwordx4 a[116:119], v4, s[8:11], s21 offen
  v_mfma_f32_32x32x16_bf16 v[128:143], a[196:199], a[52:55], v[128:143]
  s_add_u32 m0, s23, 18432
  s_add_u32 s21, s21, 1024
  buffer_load_dwordx4 v5, s[12:15], s22 offen lds
  v_mfma_f32_32x32x16_bf16 v[144:159], a[196:199], a[56:59], v[144:159]
  buffer_load_dwordx4 v6, s[12:15], s22 offen offset:1024 lds
  s_add_u32 s22, s22, 16384
  s_waitcnt lgkmcnt(0)
  v_mfma_f32_32x32x16_bf16 v[64:79], a[200:203], a[60:63], v[64:79]
  s_waitcnt vmcnt(15)
  ds_read_b64_tr_b16 a[192:193], v7 offset:12288
  ds_read_b64_tr_b16 a[194:195], v7 offset:12800
  v_mfma_f32_32x32x16_bf16 v[80:95], a[200:203], a[64:67], v[80:95]
  ds_read_b64_tr_b16 a[196:197], v8 offset:12288
  ds_read_b64_tr_b16 a[198:199], v8 offset:12800
  buffer_load_dwordx4 a[120:123], v2, s[8:11], s21 offen
  v_mfma_f32_32x32x16_bf16 v[96:111], a[200:203], a[68:71], v[96:111]
  buffer_load_dwordx4 a[124:127], v3, s[8:11], s21 offen
  v_mfma_f32_32x32x16_bf16 v[112:127], a[204:207], a[60:63], v[112:127]
  buffer_load_dwordx4 a[128:131], v4, s[8:11], s21 offen
  v_mfma_f32_32x32x16_bf16 v[128:143], a[204:207], a[64:67], v[128:143]
  s_add_u32 m0, s23, 20480
  s_add_u32 s21, s21, 1024
  buffer_load_dwordx4 v5, s[12:15], s22 offen lds
  v_mfma_f32_32x32x16_bf16 v[144:159], a[204:207], a[68:71], v[144:159]
  buffer_load_dwordx4 v6, s[12:15], s22 offen offset:1024 lds
  s_add_u32 s22, s22, 16384
  s_waitcnt lgkmcnt(0)
  v_mfma_f32_32x32x16_bf16 v[64:79], a[192:195], a[72:75], v[64:79]
  s_waitcnt vmcnt(15)
  ds_read_b64_tr_b16 a[200:201], v7 offset:14336
  ds_read_b64_tr_b16 a[202:203], v7 offset:14848
  v_mfma_f32_32x32x16_bf16 v[80:95], a[192:195], a[76:79], v[80:95]
  ds_read_b64_tr_b16 a[204:205], v8 offset:14336
  ds_read_b64_tr_b16 a[206:207], v8 offset:14848
  buffer_load_dwordx4 a[132:135], v2, s[8:11], s21 offen
  v_mfma_f32_32x32x16_bf16 v[96:111], a[192:195], a[80:83], v[96:111]
  buffer_load_dwordx4 a[136:139], v3, s[8:11], s21 offen
  v_mfma_f32_32x32x16_bf16 v[112:127], a[196:199], a[72:75], v[112:127]
  buffer_load_dwordx4 a[140:143], v4, s[8:11], s21 offen
  v_mfma_f32_32x32x16_bf16 v[128:143], a[196:199], a[76:79], v[128:143]
  s_add_u32 m0, s23, 22528
  s_add_u32 s21, s21, 1024
  buffer_load_dwordx4 v5, s[12:15], s22 offen lds
  v_mfma_f32_32x32x16_bf16 v[144:159], a[196:199], a[80:83], v[144:159]
  buffer_load_dwordx4 v6, s[12:15], s22 offen offset:1024 lds
  s_add_u32 s22, s22, 16384
  s_waitcnt lgkmcnt(0)
  v_mfma_f32_32x32x16_bf16 v[64:79], a[200:203], a[84:87], v[64:79]
  s_waitcnt vmcnt(15)
  ds_read_b64_tr_b16 a[192:193], v7 offset:16384
  ds_read_b64_tr_b16 a[194:195], v7 offset:16896
  v_mfma_f32_32x32x16_bf16 v[80:95], a[200:203], a[88:91], v[80:95]
  ds_read_b64_tr_b16 a[196:197], v8 offset:16384
  ds_read_b64_tr_b16 a[198:199], v8 offset:16896
  buffer_load_dwordx4 a[144:147], v2, s[8:11], s21 offen
  v_mfma_f32_32x32x16_bf16 v[96:111], a[200:203], a[92:95], v[96:111]
  buffer_load_dwordx4 a[148:151], v3, s[8:11], s21 offen
  v_mfma_f32_32x32x16_bf16 v[112:127], a[204:207], a[84:87], v[112:127]
  buffer_load_dwordx4 a[152:155], v4, s[8:11], s21 offen
  v_mfma_f32_32x32x16_bf16 v[128:143], a[204:207], a[88:91], v[128:143]
  s_add_u32 m0, s23, 24576
  s_add_u32 s21, s21, 1024
  buffer_load_dwordx4 v5, s[12:15], s22 offen lds
  v_mfma_f32_32x32x16_bf16 v[144:159], a[204:207], a[92:95], v[144:159]
  buffer_load_dwordx4 v6, s[12:15], s22 offen offset:1024 lds
  s_add_u32 s22, s22, 16384
  s_waitcnt lgkmcnt(0)
  v_mfma_f32_32x32x16_bf16 v[64:79], a[192:195], a[96:99], v[64:79]
  s_waitcnt vmcnt(15)
  ds_read_b64_tr_b16 a[200:201], v7 offset:18432
  ds_read_b64_tr_b16 a[202:203], v7 offset:18944
  v_mfma_f32_32x32x16_bf16 v[80:95], a[192:195], a[100:103], v[80:95]
  ds_read_b64_tr_b16 a[204:205], v8 offset:18432
  ds_read_b64_tr_b16 a[206:207], v8 offset:18944
  buffer_load_dwordx4 a[156:159], v2, s[8:11], s21 offen
  v_mfma_f32_32x32x16_bf16 v[96:111], a[192:195], a[104:107], v[96:111]
  buffer_load_dwordx4 a[160:163], v3, s[8:11], s21 offen
  v_mfma_f32_32x32x16_bf16 v[112:127], a[196:199], a[96:99], v[112:127]
  buffer_load_dwordx4 a[164:167], v4, s[8:11], s21 offen
  v_mfma_f32_32x32x16_bf16 v[128:143], a[196:199], a[100:103], v[128:143]
  s_add_u32 m0, s23, 26624
  s_add_u32 s21, s21, 1024
  buffer_load_dwordx4 v5, s[12:15], s22 offen lds
  v_mfma_f32_32x32x16_bf16 v[144:159], a[196:199], a[104:107], v[144:159]
  buffer_load_dwordx4 v6, s[12:15], s22 offen offset:1024 lds
  s_add_u32 s22, s22, 16384
  s_waitcnt lgkmcnt(0)
  v_mfma_f32_32x32x16_bf16 v[64:79], a[200:203], a[108:111], v[64:79]
  s_waitcnt vmcnt(15)
  ds_read_b64_tr_b16 a[192:193], v7 offset:20480
  ds_read_b64_tr_b16 a[194:195], v7 offset:20992
  v_mfma_f32_32x32x16_bf16 v[80:95], a[200:203], a[112:115], v[80:95]
  ds_read_b64_tr_b16 a[196:197], v8 offset:20480
  ds_read_b64_tr_b16 a[198:199], v8 offset:20992
  buffer_load_dwordx4 a[168:171], v2, s[8:11], s21 offen
  v_mfma_f32_32x32x16_bf16 v[96:111], a[200:203], a[116:119], v[96:111]
  buffer_load_dwordx4 a[172:175], v3, s[8:11], s21 offen
  v_mfma_f32_32x32x16_bf16 v[112:127], a[204:207], a[108:111], v[112:127]
  buffer_load_dwordx4 a[176:179], v4, s[8:11], s21 offen
  v_mfma_f32_32x32x16_bf16 v[128:143], a[204:207], a[112:115], v[128:143]
  s_add_u32 m0, s23, 28672
  s_add_u32 s21, s21, 1024
  buffer_load_dwordx4 v5, s[12:15], s22 offen lds
  v_mfma_f32_32x32x16_bf16 v[144:159], a[204:207], a[116:119], v[144:159]
  buffer_load_dwordx4 v6, s[12:15], s22 offen offset:1024 lds
  s_add_u32 s22, s22, 16384
  s_waitcnt lgkmcnt(0)
  v_mfma_f32_32x32x16_bf16 v[64:79], a[192:195], a[120:123], v[64:79]
  s_waitcnt vmcnt(15)
  ds_read_b64_tr_b16 a[200:201], v7 offset:22528
  ds_read_b64_tr_b16 a[202:203], v7 offset:23040
  v_mfma_f32_32x32x16_bf16 v[80:95], a[192:195], a[124:127], v[80:95]
  ds_read_b64_tr_b16 a[204:205], v8 offset:22528
  ds_read_b64_tr_b16 a[206:207], v8 offset:23040
  buffer_load_dwordx4 a[180:183], v2, s[8:11], s21 offen
  v_mfma_f32_32x32x16_bf16 v[96:111], a[192:195], a[128:131], v[96:111]
  buffer_load_dwordx4 a[184:187], v3, s[8:11], s21 offen
  v_mfma_f32_32x32x16_bf16 v[112:127], a[196:199], a[120:123], v[112:127]
  buffer_load_dwordx4 a[188:191], v4, s[8:11], s21 offen
  v_mfma_f32_32x32x16_bf16 v[128:143], a[196:199], a[124:127], v[128:143]
  s_add_u32 m0, s23, 30720
  s_add_u32 s21, s21, 1024
  buffer_load_dwordx4 v5, s[12:15], s22 offen lds
  v_mfma_f32_32x32x16_bf16 v[144:159], a[196:199], a[128:131], v[144:159]
  buffer_load_dwordx4 v6, s[12:15], s22 offen offset:1024 lds
  s_add_u32 s22, s22, 16384
  s_waitcnt lgkmcnt(0)
  v_mfma_f32_32x32x16_bf16 v[64:79], a[200:203], a[132:135], v[64:79]
  s_waitcnt vmcnt(15)
  ds_read_b64_tr_b16 a[192:193], v7 offset:24576
  ds_read_b64_tr_b16 a[194:195], v7 offset:25088
  v_mfma_f32_32x32x16_bf16 v[80:95], a[200:203], a[136:139], v[80:95]
  ds_read_b64_tr_b16 a[196:197], v8 offset:24576
  ds_read_b64_tr_b16 a[198:199], v8 offset:25088
  v_mfma_f32_32x32x16_bf16 v[96:111], a[200:203], a[140:143], v[96:111]
  v_mfma_f32_32x32x16_bf16 v[112:127], a[204:207], a[132:135], v[112:127]
  v_mfma_f32_32x32x16_bf16 v[128:143], a[204:207], a[136:139], v[128:143]
  v_mfma_f32_32x32x16_bf16 v[144:159], a[204:207], a[140:143], v[144:159]
  s_waitcnt lgkmcnt(0)
  v_mfma_f32_32x32x16_bf16 v[64:79], a[192:195], a[144:147], v[64:79]
  s_waitcnt vmcnt(10)
  ds_read_b64_tr_b16 a[200:201], v7 offset:26624
  ds_read_b64_tr_b16 a[202:203], v7 offset:27136
  v_mfma_f32_32x32x16_bf16 v[80:95], a[192:195], a[148:151], v[80:95]
  ds_read_b64_tr_b16 a[204:205], v8 offset:26624
  ds_read_b64_tr_b16 a[206:207], v8 offset:27136
  v_mfma_f32_32x32x16_bf16 v[96:111], a[192:195], a[152:155], v[96:111]
  v_mfma_f32_32x32x16_bf16 v[112:127], a[196:199], a[144:147], v[112:127]
  v_mfma_f32_32x32x16_bf16 v[128:143], a[196:199], a[148:151], v[128:143]
  v_mfma_f32_32x32x16_bf16 v[144:159], a[196:199], a[152:155], v[144:159]
  s_waitcnt lgkmcnt(0)
  v_mfma_f32_32x32x16_bf16 v[64:79], a[200:203], a[156:159], v[64:79]
  s_waitcnt vmcnt(5)
  ds_read_b64_tr_b16 a[192:193], v7 offset:28672
  ds_read_b64_tr_b16 a[194:195], v7 offset:29184
  v_mfma_f32_32x32x16_bf16 v[80:95], a[200:203], a[160:163], v[80:95]
  ds_read_b64_tr_b16 a[196:197], v8 offset:28672
  ds_read_b64_tr_b16 a[198:199], v8 offset:29184
  v_mfma_f32_32x32x16_bf16 v[96:111], a[200:203], a[164:167], v[96:111]
  v_mfma_f32_32x32x16_bf16 v[112:127], a[204:207], a[156:159], v[112:127]
  v_mfma_f32_32x32x16_bf16 v[128:143], a[204:207], a[160:163], v[128:143]
  v_mfma_f32_32x32x16_bf16 v[144:159], a[204:207], a[164:167], v[144:159]
  s_waitcnt lgkmcnt(0)
  v_mfma_f32_32x32x16_bf16 v[64:79], a[192:195], a[168:171], v[64:79]
  s_waitcnt vmcnt(0)
  ds_read_b64_tr_b16 a[200:201], v7 offset:30720
  ds_read_b64_tr_b16 a[202:203], v7 offset:31232
  v_mfma_f32_32x32x16_bf16 v[80:95], a[192:195], a[172:175], v[80:95]
  ds_read_b64_tr_b16 a[204:205], v8 offset:30720
  ds_read_b64_tr_b16 a[206:207], v8 offset:31232
  v_mfma_f32_32x32x16_bf16 v[96:111], a[192:195], a[176:179], v[96:111]
  v_mfma_f32_32x32x16_bf16 v[112:127], a[196:199], a[168:171], v[112:127]
  v_mfma_f32_32x32x16_bf16 v[128:143], a[196:199], a[172:175], v[128:143]
  v_mfma_f32_32x32x16_bf16 v[144:159], a[196:199], a[176:179], v[144:159]
  s_waitcnt lgkmcnt(0)
  v_mfma_f32_32x32x16_bf16 v[64:79], a[200:203], a[180:183], v[64:79]
  v_mfma_f32_32x32x16_bf16 v[80:95], a[200:203], a[184:187], v[80:95]
  v_mfma_f32_32x32x16_bf16 v[96:111], a[200:203], a[188:191], v[96:111]
  v_mfma_f32_32x32x16_bf16 v[112:127], a[204:207], a[180:183], v[112:127]
  v_mfma_f32_32x32x16_bf16 v[128:143], a[204:207], a[184:187], v[128:143]
  v_mfma_f32_32x32x16_bf16 v[144:159], a[204:207], a[188:191], v[144:159]
  s_nop 7
  s_nop 7
  ds_write_b128 v10, v[64:67] offset:0
  ds_write_b128 v10, v[68:71] offset:1024
  ds_write_b128 v10, v[80:83] offset:2048
  ds_write_b128 v10, v[84:87] offset:3072
  ds_write_b128 v10, v[96:99] offset:4096
  ds_write_b128 v10, v[100:103] offset:5120
  ds_write_b128 v10, v[72:75] offset:6144
  ds_write_b128 v10, v[76:79] offset:7168
  ds_write_b128 v10, v[88:91] offset:8192
  ds_write_b128 v10, v[92:95] offset:9216
  ds_write_b128 v10, v[104:107] offset:10240
  ds_write_b128 v10, v[108:111] offset:11264
  ds_write_b128 v10, v[112:115] offset:12288
  ds_write_b128 v10, v[116:119] offset:13312
  ds_write_b128 v10, v[128:131] offset:14336
  ds_write_b128 v10, v[132:135] offset:15360
  ds_write_b128 v10, v[144:147] offset:16384
  ds_write_b128 v10, v[148:151] offset:17408
  ds_write_b128 v10, v[120:123] offset:18432
  ds_write_b128 v10, v[124:127] offset:19456
  ds_write_b128 v10, v[136:139] offset:20480
  ds_write_b128 v10, v[140:143] offset:21504
  ds_write_b128 v10, v[152:155] offset:22528
  ds_write_b128 v10, v[156:159] offset:23552
  s_waitcnt lgkmcnt(0)
  s_barrier
  ds_read_b128 v[64:67], v9 offset:0
  ds_read_b128 v[68:71], v9 offset:1024
  ds_read_b128 v[72:75], v9 offset:2048
  ds_read_b128 v[76:79], v9 offset:3072
  ds_read_b128 v[80:83], v9 offset:4096
  ds_read_b128 v[84:87], v9 offset:5120
  ds_read_b128 v[88:91], v9 offset:32768
  ds_read_b128 v[92:95], v9 offset:33792
  ds_read_b128 v[96:99], v9 offset:34816
  ds_read_b128 v[100:103], v9 offset:35840
  ds_read_b128 v[104:107], v9 offset:36864
  ds_read_b128 v[108:111], v9 offset:37888
  v_add_u32 v12, 0x10000, v9
  ds_read_b128 v[112:115], v12 offset:0
  ds_read_b128 v[116:119], v12 offset:1024
  ds_read_b128 v[120:123], v12 offset:2048
  ds_read_b128 v[124:127], v12 offset:3072
  ds_read_b128 v[128:131], v12 offset:4096
  ds_read_b128 v[132:135], v12 offset:5120
  ds_read_b128 v[136:139], v12 offset:32768
  ds_read_b128 v[140:143], v12 offset:33792
  ds_read_b128 v[144:147], v12 offset:34816
  ds_read_b128 v[148:151], v12 offset:35840
  ds_read_b128 v[152:155], v12 offset:36864
  ds_read_b128 v[156:159], v12 offset:37888
  s_waitcnt lgkmcnt(0)
  v_add_f32 v64, v64, v88
  v_add_f32 v112, v112, v136
  v_add_f32 v65, v65, v89
  v_add_f32 v113, v113, v137
  v_add_f32 v66, v66, v90
  v_add_f32 v114, v114, v138
  v_add_f32 v67, v67, v91
  v_add_f32 v115, v115, v139
  v_add_f32 v68, v68, v92
  v_add_f32 v116, v116, v140
  v_add_f32 v69, v69, v93
  v_add_f32 v117, v117, v141
  v_add_f32 v70, v70, v94
  v_add_f32 v118, v118, v142
  v_add_f32 v71, v71, v95
  v_add_f32 v119, v119, v143
  v_add_f32 v64, v64, v112
  v_add_f32 v65, v65, v113
  v_add_f32 v66, v66, v114
  v_add_f32 v67, v67, v115
  v_add_f32 v68, v68, v116
  v_add_f32 v69, v69, v117
  v_add_f32 v70, v70, v118
  v_add_f32 v71, v71, v119
  v_cvt_pk_bf16_f32 v160, v64, v65
  v_cvt_pk_bf16_f32 v161, v66, v67
  v_cvt_pk_bf16_f32 v162, v68, v69
  v_cvt_pk_bf16_f32 v163, v70, v71
  s_mov_b32 s7, 0
  buffer_store_dwordx4 v[160:163], v11, s[16:19], s7 offen
  v_add_f32 v72, v72, v96
  v_add_f32 v120, v120, v144
  v_add_f32 v73, v73, v97
  v_add_f32 v121, v121, v145
  v_add_f32 v74, v74, v98
  v_add_f32 v122, v122, v146
  v_add_f32 v75, v75, v99
  v_add_f32 v123, v123, v147
  v_add_f32 v76, v76, v100
  v_add_f32 v124, v124, v148
  v_add_f32 v77, v77, v101
  v_add_f32 v125, v125, v149
  v_add_f32 v78, v78, v102
  v_add_f32 v126, v126, v150
  v_add_f32 v79, v79, v103
  v_add_f32 v127, v127, v151
  v_add_f32 v72, v72, v120
  v_add_f32 v73, v73, v121
  v_add_f32 v74, v74, v122
  v_add_f32 v75, v75, v123
  v_add_f32 v76, v76, v124
  v_add_f32 v77, v77, v125
  v_add_f32 v78, v78, v126
  v_add_f32 v79, v79, v127
  v_cvt_pk_bf16_f32 v164, v72, v73
  v_cvt_pk_bf16_f32 v165, v74, v75
  v_cvt_pk_bf16_f32 v166, v76, v77
  v_cvt_pk_bf16_f32 v167, v78, v79
  s_mov_b32 s7, 65536
  buffer_store_dwordx4 v[164:167], v11, s[16:19], s7 offen
  v_add_f32 v80, v80, v104
  v_add_f32 v128, v128, v152
  v_add_f32 v81, v81, v105
  v_add_f32 v129, v129, v153
  v_add_f32 v82, v82, v106
  v_add_f32 v130, v130, v154
  v_add_f32 v83, v83, v107
  v_add_f32 v131, v131, v155
  v_add_f32 v84, v84, v108
  v_add_f32 v132, v132, v156
  v_add_f32 v85, v85, v109
  v_add_f32 v133, v133, v157
  v_add_f32 v86, v86, v110
  v_add_f32 v134, v134, v158
  v_add_f32 v87, v87, v111
  v_add_f32 v135, v135, v159
  v_add_f32 v80, v80, v128
  v_add_f32 v81, v81, v129
  v_add_f32 v82, v82, v130
  v_add_f32 v83, v83, v131
  v_add_f32 v84, v84, v132
  v_add_f32 v85, v85, v133
  v_add_f32 v86, v86, v134
  v_add_f32 v87, v87, v135
  v_cvt_pk_bf16_f32 v168, v80, v81
  v_cvt_pk_bf16_f32 v169, v82, v83
  v_cvt_pk_bf16_f32 v170, v84, v85
  v_cvt_pk_bf16_f32 v171, v86, v87
  s_mov_b32 s7, 131072
  buffer_store_dwordx4 v[168:171], v11, s[16:19], s7 offen
k2_end:
  s_endpgm
.section .rodata,"a"
.p2align 6
.amdhsa_kernel k1_kernel
  .amdhsa_next_free_vgpr 512
  .amdhsa_next_free_sgpr 102
  .amdhsa_accum_offset 256
  .amdhsa_group_segment_fixed_size 0
  .amdhsa_kernarg_size 104
  .amdhsa_user_sgpr_count 2
  .amdhsa_user_sgpr_kernarg_segment_ptr 1
  .amdhsa_system_sgpr_workgroup_id_x 1
.end_amdhsa_kernel
.p2align 6
.amdhsa_kernel k2_kernel
  .amdhsa_next_free_vgpr 512
  .amdhsa_next_free_sgpr 102
  .amdhsa_accum_offset 256
  .amdhsa_group_segment_fixed_size 0
  .amdhsa_kernarg_size 104
  .amdhsa_user_sgpr_count 2
  .amdhsa_user_sgpr_kernarg_segment_ptr 1
  .amdhsa_system_sgpr_workgroup_id_x 1
.end_amdhsa_kernel
```
